```python
import torch

def _softmax(x, axis=-1):
    return torch.softmax(x, dim=axis)
def _gelu(x):
    return torch.nn.functional.gelu(x, approximate="tanh")
def _silu(x):
    return torch.nn.functional.silu(x)
def _sigmoid(x):
    return torch.sigmoid(x)
def _layernorm(x, axis=-1, eps=1e-5):
    m = x.mean(dim=axis, keepdim=True)
    v = x.var(dim=axis, keepdim=True, unbiased=False)
    return (x - m) / torch.sqrt(v + eps)
def _scatter_add(tgt, idx, src, axis=0):
    return tgt.clone().index_add_(axis, idx, src)
def _segment_sum(src, seg, n):
    out = torch.zeros((n,) + src.shape[1:], dtype=src.dtype)
    return out.index_add_(0, seg, src)
def _pad(x, pw):
    flat = tuple(v for pair in reversed(pw) for v in pair)
    return torch.nn.functional.pad(x, flat)

kernel_name = 'gated_mix__mha_block_cached__dense_activation_squared_relu__decode'

def setup_inputs():

    _w = (lambda a: (lambda t: t.to(torch.bfloat16) if t.is_floating_point() else t)(torch.as_tensor(a)))
    def _A_setup():
        B, Sq, D = 2, 1, 448
        H, Sk, Dh = 16, 4096, 256
        return {
            "x": _w((lambda *s: torch.randn(*s, dtype=torch.bfloat16) * 0.05)(B, Sq, D)),
            "k_cache": _w((lambda *s: torch.randn(*s, dtype=torch.bfloat16) * 6.4)(B, H, Sk, Dh)),
            "v_cache": _w((lambda *s: torch.randn(*s, dtype=torch.bfloat16) * 3.2)(B, H, Sk, Dh)),
            "wq": _w((lambda *s: torch.randn(*s, dtype=torch.bfloat16) * 6.4)(D, H * Dh) * (D ** -0.5)),
            "wo": _w((lambda *s: torch.randn(*s, dtype=torch.bfloat16) * 3.2)(H * Dh, D) * ((H * Dh) ** -0.5)),
        }
    _A_in = _A_setup()

    def _B_setup():
        B, S, D, F = 2, 1, 448, 1792
        return {
            "x": _w((lambda *s: torch.randn(*s, dtype=torch.bfloat16) * 0.05)(B, S, D)),
            "w1": _w((lambda *s: torch.randn(*s, dtype=torch.bfloat16) * 0.2)(D, F)),
            "b1": _w((lambda *s: torch.randn(*s, dtype=torch.bfloat16) * 0.2)(F)),
            "w2": _w((lambda *s: torch.randn(*s, dtype=torch.bfloat16) * 0.2)(F, D)),
            "b2": _w((lambda *s: torch.randn(*s, dtype=torch.bfloat16) * 0.4)(D)),
        }
    _B_in = _B_setup()

    return {
        "A_x": _A_in["x"],
        "A_k_cache": _A_in["k_cache"],
        "A_v_cache": _A_in["v_cache"],
        "A_wq": _A_in["wq"],
        "A_wo": _A_in["wo"],
        "B_x": _B_in["x"],
        "B_w1": _B_in["w1"],
        "B_b1": _B_in["b1"],
        "B_w2": _B_in["w2"],
        "B_b2": _B_in["b2"],
        "gate_w": _w((lambda *s: torch.randn(*s, dtype=torch.bfloat16) * 0.1)(448) * 16.0),
    }

def reference(A_x, A_k_cache, A_v_cache, A_wq, A_wo, B_x, B_w1, B_b1, B_w2, B_b2, gate_w):
    def _A_ref(x, k_cache, v_cache, wq, wo):
        B, Sq, D = x.shape
        H, Dh = 16, 256
        q = (lambda x, *d: x.permute(*d))((x @ wq).reshape(B, Sq, H, Dh), 0, 2, 1, 3)
        scores = torch.einsum("bhqd,bhkd->bhqk", q, k_cache) * (Dh ** -0.5)
        p = _softmax(scores, axis=-1)
        o = torch.einsum("bhqk,bhkd->bhqd", p, v_cache)
        return (lambda x, *d: x.permute(*d))(o, 0, 2, 1, 3).reshape(B, Sq, H * Dh) @ wo

    def _B_ref(x, w1, b1, w2, b2):
        h = torch.einsum("bsd,df->bsf", x, w1) + b1
        zero = torch.zeros_like(h)
        r = torch.where(h > zero, h, zero)
        h = r * r
        out = torch.einsum("bsf,fd->bsd", h, w2) + b2
        return out

    x = A_x
    g = _sigmoid((x * gate_w).sum(-1, keepdims=True))
    a = _A_ref(x, A_k_cache, A_v_cache, A_wq, A_wo)
    b = _B_ref(x, B_w1, B_b1, B_w2, B_b2)
    return g * a + (1 - g) * b
```

```asm
; @launch grid=(256,1,1) block=(512,1,1) lds=20480
.amdgcn_target "amdgcn-amd-amdhsa--gfx950"
.text
.globl gated_mix__mha_block_cached__dense_activation_squared_relu__decode_kernel
.p2align 8
.type gated_mix__mha_block_cached__dense_activation_squared_relu__decode_kernel,@function
gated_mix__mha_block_cached__dense_activation_squared_relu__decode_kernel:
  s_cmp_ge_u32 s2, 256
  s_cbranch_scc1 L_end
  s_load_dwordx8 s[4:11], s[0:1], 0
  s_load_dwordx8 s[12:19], s[0:1], 32
  s_load_dwordx8 s[20:27], s[0:1], 64
  s_load_dwordx4 s[28:31], s[0:1], 96
  v_lshrrev_b32 v6, 6, v0
  v_and_b32 v1, 63, v0
  v_readfirstlane_b32 s3, v6
  s_and_b32 s86, s2, 7
  s_lshl_b32 s76, s86, 1
  s_bfe_u32 s81, s2, 0x10003
  s_add_u32 s76, s76, s81
  s_bfe_u32 s77, s2, 0x10004
  s_lshr_b32 s78, s2, 5
  s_lshl_b32 s87, s77, 4
  s_add_u32 s87, s87, s76
  s_lshl_b32 s80, s87, 3
  s_add_u32 s80, s80, s78
  s_lshl_b32 s81, s80, 18
  s_mul_i32 s82, s3, 4096
  s_add_u32 s81, s81, s82
  v_lshlrev_b32 v7, 4, v1
  v_add_u32 v2, s81, v7
  s_mov_b32 s34, 0x4000000
  s_mov_b32 s35, 0x20000
  s_lshl_b32 s79, s77, 3
  s_add_u32 s79, s79, s78
  s_and_b32 s92, s79, 3
  s_lshr_b32 s93, s79, 2
  s_lshr_b32 s94, s2, 3
  v_lshrrev_b32 v23, 3, v1
  v_and_b32 v25, 7, v1
  v_lshlrev_b32 v24, 4, v25
  s_mul_i32 s81, s93, 112
  s_lshl_b32 s82, s3, 4
  s_add_u32 s81, s81, s82
  v_lshl_add_u32 v21, v23, 1, s81
  s_lshl_b32 s81, s76, 9
  s_lshl_b32 s82, s92, 7
  s_add_u32 s81, s81, s82
  s_lshl_b32 s82, s94, 7
  s_cmp_ge_u32 s2, 224
  s_cselect_b32 s82, 0x80000000, s82
  s_cmp_eq_u32 s3, 7
  s_cselect_b32 s81, 0x80000000, s81
  s_cselect_b32 s82, 0x80000000, s82
  v_lshl_add_u32 v3, v21, 13, v24
  v_add_u32 v3, s81, v3
  s_mul_i32 s81, s86, 56
  s_lshl_b32 s91, s3, 3
  s_add_u32 s81, s81, s91
  v_add_u32 v22, s81, v23
  v_mul_u32_u24 v20, 0xe00, v22
  v_add3_u32 v20, v20, v24, s82
  v_and_b32 v22, -2, v22
  s_mov_b32 s100, 0xcccccccc
  s_mov_b32 s101, 0xcccccccc
  v_cndmask_b32 v21, v21, v22, s[100:101]
  v_and_b32 v22, 1, v1
  v_mul_u32_u24 v22, 0x380, v22
  v_lshl_add_u32 v21, v21, 1, v22
  s_mov_b32 s42, 3670016
  s_mov_b32 s43, 0x20000
  s_mov_b32 s50, 1605632
  s_mov_b32 s51, 0x20000
  s_mov_b32 s62, 1792
  s_mov_b32 s63, 0x20000
  s_waitcnt lgkmcnt(0)
  s_mov_b32 s32, s6
  s_mov_b32 s33, s7
  buffer_load_dwordx4 v[64:67], v2, s[32:35], 0 offen offset:0 nt
  buffer_load_dwordx4 v[68:71], v2, s[32:35], 0 offen offset:1024 nt
  buffer_load_dwordx4 v[72:75], v2, s[32:35], 0 offen offset:2048 nt
  buffer_load_dwordx4 v[76:79], v2, s[32:35], 0 offen offset:3072 nt
  s_mov_b32 s40, s10
  s_mov_b32 s41, s11
  buffer_load_dwordx4 v[80:83], v3, s[40:43], 0 offen nt
  s_mov_b32 s83, 8192
  buffer_load_dwordx4 v[84:87], v3, s[40:43], s83 offen nt
  s_mov_b32 s48, s16
  s_mov_b32 s49, s17
  buffer_load_dwordx4 v[88:91], v20, s[48:51], 0 offen nt
  s_mov_b32 s60, s4
  s_mov_b32 s61, s5
  buffer_load_dword v36, v21, s[60:63], 0 offen
  s_load_dword s90, s[30:31], 0
  v_lshrrev_b32 v6, 5, v1
  s_mov_b32 s84, 0x05040100
  s_mov_b32 s85, 0x07060302
  v_lshrrev_b32 v12, 4, v1
  v_bfe_u32 v13, v1, 3, 1
  v_lshl_add_u32 v12, v13, 2, v12
  v_lshl_add_u32 v11, v25, 3, v12
  s_lshl_b32 s81, s3, 8
  v_lshl_add_u32 v34, v11, 2, s81
  s_lshl_b32 s81, s3, 10
  v_lshl_add_u32 v29, v11, 3, s81
  v_lshlrev_b32 v26, 4, v13
  s_mov_b32 s56, s30
  s_mov_b32 s57, s31
  s_mov_b32 s58, 1572864
  s_mov_b32 s59, 0x20000
  s_lshl_b32 s81, s76, 13
  s_lshl_b32 s82, s92, 9
  s_add_u32 s81, s81, s82
  s_lshl_b32 s82, s93, 11
  s_add_u32 s81, s81, s82
  s_add_u32 s92, s81, 65536
  s_lshl_b32 s81, s94, 9
  s_mul_i32 s82, s86, 14336
  s_add_u32 s81, s81, s82
  s_add_u32 s81, s81, 327680
  s_cmp_ge_u32 s2, 224
  s_cselect_b32 s81, 0x80000000, s81
  s_cmp_eq_u32 s3, 0
  s_cselect_b32 s92, s92, s81
  s_mov_b32 s81, 114688
  s_cselect_b32 s81, 0x20000, s81
  v_and_b32 v30, 31, v1
  v_lshlrev_b32 v27, 3, v30
  v_lshlrev_b32 v30, 4, v30
  v_mul_lo_u32 v11, v6, s81
  v_add3_u32 v30, v30, v11, s92
  v_lshrrev_b32 v11, 5, v0
  v_lshl_add_u32 v27, v11, 11, v27
  v_mov_b32 v11, 0
  ds_write_b32 v11, v11 offset:576
  s_waitcnt vmcnt(7)
  s_mov_b32 s83, 32768
  buffer_load_dwordx4 v[92:95], v2, s[32:35], s83 offen offset:0 nt
  s_waitcnt vmcnt(7)
  buffer_load_dwordx4 v[96:99], v2, s[32:35], s83 offen offset:1024 nt
  s_waitcnt vmcnt(7)
  buffer_load_dwordx4 v[100:103], v2, s[32:35], s83 offen offset:2048 nt
  s_waitcnt vmcnt(7)
  buffer_load_dwordx4 v[104:107], v2, s[32:35], s83 offen offset:3072 nt
  s_waitcnt vmcnt(4)
  v_mov_b32_dpp v37, v36 quad_perm:[0,0,0,0] row_mask:0xf bank_mask:0xf
  v_mov_b32_dpp v38, v36 quad_perm:[1,1,1,1] row_mask:0xf bank_mask:0xf
  v_mov_b32_dpp v39, v36 quad_perm:[2,2,2,2] row_mask:0xf bank_mask:0xf
  v_mov_b32_dpp v40, v36 quad_perm:[3,3,3,3] row_mask:0xf bank_mask:0xf
  v_perm_b32 v8, v84, v80, s84
  v_perm_b32 v84, v84, v80, s85
  v_perm_b32 v80, v85, v81, s84
  v_perm_b32 v85, v85, v81, s85
  v_perm_b32 v81, v86, v82, s84
  v_perm_b32 v86, v86, v82, s85
  v_perm_b32 v82, v87, v83, s84
  v_perm_b32 v87, v87, v83, s85
  v_dot2_f32_bf16 v236, v8, v37, 0
  v_dot2_f32_bf16 v237, v84, v37, 0
  v_dot2_f32_bf16 v238, v80, v37, 0
  v_dot2_f32_bf16 v239, v85, v37, 0
  v_dot2_f32_bf16 v240, v81, v37, 0
  v_dot2_f32_bf16 v241, v86, v37, 0
  v_dot2_f32_bf16 v242, v82, v37, 0
  v_dot2_f32_bf16 v243, v87, v37, 0
  v_dot2_f32_bf16 v244, v8, v38, 0
  v_dot2_f32_bf16 v245, v84, v38, 0
  v_dot2_f32_bf16 v246, v80, v38, 0
  v_dot2_f32_bf16 v247, v85, v38, 0
  v_dot2_f32_bf16 v248, v81, v38, 0
  v_dot2_f32_bf16 v249, v86, v38, 0
  v_dot2_f32_bf16 v250, v82, v38, 0
  v_dot2_f32_bf16 v251, v87, v38, 0
  s_waitcnt vmcnt(3)
  s_mov_b32 s83, 65536
  buffer_load_dwordx4 v[108:111], v2, s[32:35], s83 offen offset:0 nt
  v_bfe_u32 v41, v39, v26, 16
  v_bfe_u32 v43, v40, v26, 16
  v_permlane16_swap_b32 v236, v237
  v_permlane16_swap_b32 v238, v239
  v_permlane16_swap_b32 v240, v241
  v_permlane16_swap_b32 v242, v243
  v_permlane16_swap_b32 v244, v245
  v_permlane16_swap_b32 v246, v247
  v_permlane16_swap_b32 v248, v249
  v_permlane16_swap_b32 v250, v251
  v_add_f32 v236, v236, v237
  v_add_f32 v238, v238, v239
  v_add_f32 v240, v240, v241
  v_add_f32 v242, v242, v243
  v_add_f32 v244, v244, v245
  v_add_f32 v246, v246, v247
  v_add_f32 v248, v248, v249
  v_add_f32 v250, v250, v251
  v_permlane32_swap_b32 v236, v238
  v_permlane32_swap_b32 v240, v242
  v_permlane32_swap_b32 v244, v246
  v_permlane32_swap_b32 v248, v250
  v_add_f32 v236, v236, v238
  v_add_f32 v240, v240, v242
  v_add_f32 v244, v244, v246
  v_add_f32 v248, v248, v250
  v_add_f32_dpp v16, v236, v236 row_ror:8 row_mask:0xf bank_mask:0x3
  v_add_f32_dpp v17, v244, v244 row_ror:8 row_mask:0xf bank_mask:0x3
  s_nop 0
  v_add_f32_dpp v16, v240, v240 row_ror:8 row_mask:0xf bank_mask:0xc
  v_add_f32_dpp v17, v248, v248 row_ror:8 row_mask:0xf bank_mask:0xc
  v_lshlrev_b32 v42, 16, v41
  v_lshlrev_b32 v44, 16, v43
  ds_write_b32 v34, v16 offset:4096
  ds_write_b32 v34, v17 offset:6144
  s_waitcnt vmcnt(3)
  buffer_load_dwordx4 v[112:115], v2, s[32:35], s83 offen offset:1024 nt
  v_dot2_f32_bf16 v236, v88, v41, 0
  v_dot2_f32_bf16 v237, v88, v42, 0
  v_dot2_f32_bf16 v238, v89, v41, 0
  v_dot2_f32_bf16 v239, v89, v42, 0
  v_dot2_f32_bf16 v240, v90, v41, 0
  v_dot2_f32_bf16 v241, v90, v42, 0
  v_dot2_f32_bf16 v242, v91, v41, 0
  v_dot2_f32_bf16 v243, v91, v42, 0
  v_dot2_f32_bf16 v244, v88, v43, 0
  v_dot2_f32_bf16 v245, v88, v44, 0
  v_dot2_f32_bf16 v246, v89, v43, 0
  v_dot2_f32_bf16 v247, v89, v44, 0
  v_dot2_f32_bf16 v248, v90, v43, 0
  v_dot2_f32_bf16 v249, v90, v44, 0
  v_dot2_f32_bf16 v250, v91, v43, 0
  v_dot2_f32_bf16 v251, v91, v44, 0
  v_permlane16_swap_b32 v236, v237
  v_permlane16_swap_b32 v238, v239
  v_permlane16_swap_b32 v240, v241
  v_permlane16_swap_b32 v242, v243
  v_permlane16_swap_b32 v244, v245
  v_permlane16_swap_b32 v246, v247
  v_permlane16_swap_b32 v248, v249
  v_permlane16_swap_b32 v250, v251
  v_add_f32 v236, v236, v237
  v_add_f32 v238, v238, v239
  v_add_f32 v240, v240, v241
  v_add_f32 v242, v242, v243
  v_add_f32 v244, v244, v245
  v_add_f32 v246, v246, v247
  v_add_f32 v248, v248, v249
  v_add_f32 v250, v250, v251
  v_permlane32_swap_b32 v236, v238
  v_permlane32_swap_b32 v240, v242
  v_permlane32_swap_b32 v244, v246
  v_permlane32_swap_b32 v248, v250
  v_add_f32 v236, v236, v238
  v_add_f32 v240, v240, v242
  v_add_f32 v244, v244, v246
  v_add_f32 v248, v248, v250
  v_add_f32_dpp v18, v236, v236 row_ror:8 row_mask:0xf bank_mask:0x3
  v_add_f32_dpp v19, v244, v244 row_ror:8 row_mask:0xf bank_mask:0x3
  s_nop 0
  v_add_f32_dpp v18, v240, v240 row_ror:8 row_mask:0xf bank_mask:0xc
  v_add_f32_dpp v19, v248, v248 row_ror:8 row_mask:0xf bank_mask:0xc
  ds_write_b32 v34, v18 offset:8192
  ds_write_b32 v34, v19 offset:10240
  s_waitcnt vmcnt(3)
  buffer_load_dwordx4 v[116:119], v2, s[32:35], s83 offen offset:2048 nt
  s_waitcnt lgkmcnt(0)
  s_mul_i32 s81, s90, 0x9E3779B1
  s_add_u32 s81, s81, 0x7F4A7C15
  v_mov_b32 v32, s81
  s_barrier
  s_cmp_ge_u32 s3, 2
  s_cbranch_scc1 L_pjdone
  ds_read_b64 v[36:37], v27 offset:4096
  ds_read_b64 v[38:39], v27 offset:4352
  ds_read_b64 v[40:41], v27 offset:4608
  ds_read_b64 v[42:43], v27 offset:4864
  ds_read_b64 v[44:45], v27 offset:5120
  ds_read_b64 v[46:47], v27 offset:5376
  ds_read_b64 v[48:49], v27 offset:5632
  ds_read_b64 v[50:51], v27 offset:5888
  s_waitcnt lgkmcnt(6)
  v_add_f32 v36, v36, v38
  v_add_f32 v37, v37, v39
  s_waitcnt lgkmcnt(4)
  v_add_f32 v40, v40, v42
  v_add_f32 v41, v41, v43
  s_waitcnt lgkmcnt(2)
  v_add_f32 v44, v44, v46
  v_add_f32 v45, v45, v47
  s_waitcnt lgkmcnt(0)
  v_add_f32 v48, v48, v50
  v_add_f32 v49, v49, v51
  v_add_f32 v36, v36, v40
  v_add_f32 v37, v37, v41
  v_add_f32 v44, v44, v48
  v_add_f32 v45, v45, v49
  v_add_f32 v36, v36, v44
  v_add_f32 v37, v37, v45
  v_mov_b32 v38, v37
  v_mov_b32 v37, v32
  v_mov_b32 v39, v32
  buffer_store_dwordx4 v[36:39], v30, s[56:59], 0 offen sc1
L_pjdone:
  s_nop 4
  s_waitcnt vmcnt(3)
  buffer_load_dwordx4 v[120:123], v2, s[32:35], s83 offen offset:3072 nt
  s_mov_b32 s36, s8
  s_mov_b32 s37, s9
  s_mov_b32 s38, 67108864
  s_mov_b32 s39, 0x20000
  s_mov_b32 s44, s12
  s_mov_b32 s45, s13
  s_mov_b32 s46, 3670016
  s_mov_b32 s47, 0x20000
  s_mov_b32 s52, s20
  s_mov_b32 s53, s21
  s_mov_b32 s54, 1605632
  s_mov_b32 s55, 0x20000
  s_mov_b32 s64, s24
  s_mov_b32 s65, s25
  s_mov_b32 s66, 896
  s_mov_b32 s67, 0x20000
  s_mov_b32 s68, s22
  s_mov_b32 s69, s23
  s_mov_b32 s70, 896
  s_mov_b32 s71, 0x20000
  s_mov_b32 s72, s26
  s_mov_b32 s73, s27
  s_mov_b32 s74, 1792
  s_mov_b32 s75, 0x20000
  s_mov_b32 s12, s18
  s_mov_b32 s13, s19
  s_mov_b32 s14, 3584
  s_mov_b32 s15, 0x20000
  s_mov_b32 s96, 0xaaaaaaaa
  s_mov_b32 s97, 0xaaaaaaaa
  s_waitcnt vmcnt(3)
  s_mov_b32 s83, 98304
  buffer_load_dwordx4 v[124:127], v2, s[32:35], s83 offen offset:0 nt
  s_cmp_ge_u32 s79, 7
  s_cselect_b32 s81, 1, 0
  s_lshl_b32 s89, s76, 1
  s_add_u32 s89, s89, s81
  s_mul_i32 s81, s81, 7
  s_sub_u32 s88, s79, s81
  s_lshl_b32 s81, s89, 3
  s_add_u32 s81, s81, s3
  s_mul_i32 s81, s81, 14336
  s_lshl_b32 s82, s88, 7
  s_add_u32 s81, s81, s82
  s_cmp_ge_u32 s79, 14
  s_cselect_b32 s81, 0x80000000, s81
  s_cselect_b32 s82, 0x80000000, s82
  v_mul_u32_u24 v4, 0x700, v23
  v_add3_u32 v4, v4, v24, s81
  s_mul_i32 s81, s89, 56
  s_lshl_b32 s91, s3, 3
  s_add_u32 s81, s81, s91
  v_add_u32 v22, s81, v23
  s_cmp_eq_u32 s3, 7
  s_cselect_b32 s82, 0x80000000, s82
  v_mul_u32_u24 v5, 0x380, v22
  v_add3_u32 v5, v5, v24, s82
  v_add_u32 v22, s81, v25
  v_lshlrev_b32 v35, 1, v22
  s_and_b32 s82, s82, 0x80000000
  s_add_u32 s82, s82, 327680
  v_lshrrev_b32 v26, 1, v22
  v_mul_u32_u24 v63, 0x3800, v23
  v_lshl_add_u32 v63, v26, 4, v63
  v_add_u32 v63, s82, v63
  v_mov_b32 v31, s91
  s_waitcnt vmcnt(3)
  buffer_load_dwordx4 v[128:131], v2, s[32:35], s83 offen offset:1024 nt
  s_lshl_b32 s81, s87, 14
  s_lshl_b32 s82, s78, 4
  s_add_u32 s81, s81, s82
  v_and_b32 v20, 3, v0
  v_cmp_eq_u32 vcc, 0, v20
  v_lshl_add_u32 v60, v0, 5, s81
  v_mov_b32 v61, 0x80000000
  v_cndmask_b32 v60, v61, v60, vcc
  v_lshrrev_b32 v59, 2, v0
  v_lshrrev_b32 v58, 3, v59
  v_lshlrev_b32 v58, 12, v58
  v_and_b32 v62, 7, v59
  v_lshl_add_u32 v58, v62, 4, v58
  s_lshl_b32 s81, s88, 16
  s_lshl_b32 s82, s89, 7
  s_add_u32 s81, s81, s82
  v_add_u32 v58, s81, v58
  v_cndmask_b32 v58, v61, v58, vcc
  v_lshlrev_b32 v59, 3, v59
  v_lshl_add_u32 v59, v20, 11, v59
  s_lshl_b32 s81, s89, 13
  s_lshl_b32 s82, s3, 10
  s_add_u32 s81, s81, s82
  v_add_u32 v61, s81, v7
  v_and_b32 v27, 31, v1
  v_lshlrev_b32 v27, 4, v27
  v_lshlrev_b32 v28, 1, v27
  v_lshl_add_u32 v28, v6, 4, v28
  v_add_u32 v28, s82, v28
  s_waitcnt vmcnt(3)
  buffer_load_dwordx4 v[132:135], v2, s[32:35], s83 offen offset:2048 nt
  s_and_b32 s81, s79, 1
  s_lshl_b32 s82, s76, 1
  s_add_u32 s81, s81, s82
  s_lshl_b32 s81, s81, 2
  s_and_b32 s82, s3, 3
  s_add_u32 s90, s81, s82
  s_cmp_ge_u32 s79, 14
  s_cselect_b32 s95, 56, 0
  s_cmp_ge_u32 s3, 4
  s_cselect_b32 s95, 0, s95
  s_cmp_ge_u32 s90, 112
  s_cselect_b32 s95, 0, s95
  s_lshl_b32 s81, s90, 12
  v_add_u32 v62, s81, v7
  s_bfe_u32 s92, s90, 0x10003
  s_mul_i32 s92, s92, 896
  s_lshr_b32 s82, s90, 4
  s_lshl_b32 s82, s82, 7
  s_and_b32 s91, s90, 7
  s_lshl_b32 s91, s91, 4
  s_add_u32 s93, s82, s91
  v_lshlrev_b32 v33, 1, v25
  s_add_u32 s81, s92, s93
  v_and_b32 v57, 0x39, v1
  v_cmp_eq_u32 vcc, 0, v57
  v_add_u32 v26, s81, v33
  v_mov_b32 v57, 0x80000000
  v_cndmask_b32 v57, v57, v26, vcc
  v_cmp_gt_u32 vcc, s95, v1
  v_mov_b32 v56, 0x80000000
  s_nop 0
  v_cndmask_b32 v56, v56, v7, vcc
  s_lshl_b32 s94, s87, 13
  s_add_u32 s94, s94, 65536
  v_lshrrev_b32 v22, 4, v1
  v_lshlrev_b32 v22, 11, v22
  v_and_b32 v21, 15, v1
  v_lshlrev_b32 v21, 2, v21
  v_lshl_add_u32 v21, v31, 3, v21
  v_lshl_add_u32 v22, v21, 2, v22
  s_waitcnt vmcnt(3)
  buffer_load_dwordx4 v[136:139], v2, s[32:35], s83 offen offset:3072 nt
  s_waitcnt vmcnt(3)
  s_mov_b32 s83, 131072
  buffer_load_dwordx4 v[140:143], v2, s[32:35], s83 offen offset:0 nt
  buffer_load_dwordx4 v[8:11], v22, s[56:59], s94 offen sc1
  s_waitcnt vmcnt(4)
  buffer_load_dwordx4 v[144:147], v2, s[32:35], s83 offen offset:1024 nt
  s_waitcnt vmcnt(4)
  buffer_load_dwordx4 v[148:151], v2, s[32:35], s83 offen offset:2048 nt
  s_waitcnt vmcnt(4)
  buffer_load_dwordx4 v[152:155], v2, s[32:35], s83 offen offset:3072 nt
  s_waitcnt vmcnt(4)
  s_mov_b32 s83, 163840
  buffer_load_dwordx4 v[156:159], v2, s[32:35], s83 offen offset:0 nt
  s_waitcnt vmcnt(4)
  s_mov_b32 s91, 131072
L_qchk:
  s_nop 4
  v_cmp_ne_u32 vcc, v9, v32
  v_cmp_ne_u32 s[98:99], v11, v32
  s_nop 0
  s_or_b64 vcc, vcc, s[98:99]
  s_cmp_lg_u64 vcc, 0
  s_cbranch_scc0 L_qok
  s_sub_u32 s91, s91, 1
  s_cbranch_scc1 L_qok
  s_sleep 2
  buffer_load_dwordx4 v[8:11], v22, s[56:59], s94 offen sc1
  s_waitcnt vmcnt(0)
  s_branch L_qchk
L_qok:
  s_nop 4
  v_permlane16_swap_b32 v8, v10
  v_add_f32 v8, v8, v10
  v_mov_b32 v10, v8
  s_nop 1
  v_permlane32_swap_b32 v8, v10
  v_add_f32 v8, v8, v10
  v_mov_b32 v10, v8
  s_nop 1
  v_permlane16_swap_b32 v8, v10
  v_cvt_pk_bf16_f32 v8, v8, v10
  ds_write_b32 v21, v8 offset:0
  s_waitcnt vmcnt(3)
  buffer_load_dwordx4 v[160:163], v2, s[32:35], s83 offen offset:1024 nt
  s_waitcnt lgkmcnt(0)
  s_barrier
  ds_read_b128 v[16:19], v27 offset:0
  s_waitcnt vmcnt(3)
  buffer_load_dwordx4 v[164:167], v2, s[32:35], s83 offen offset:2048 nt
  s_waitcnt lgkmcnt(0)
  v_dot2_f32_bf16 v20, v64, v16, 0
  v_dot2_f32_bf16 v20, v65, v17, v20
  v_dot2_f32_bf16 v20, v66, v18, v20
  v_dot2_f32_bf16 v20, v67, v19, v20
  v_dot2_f32_bf16 v21, v68, v16, 0
  v_dot2_f32_bf16 v21, v69, v17, v21
  v_dot2_f32_bf16 v21, v70, v18, v21
  v_dot2_f32_bf16 v21, v71, v19, v21
  s_nop 2
  v_permlane16_swap_b32 v20, v21
  v_add_f32 v20, v20, v21
  v_dot2_f32_bf16 v22, v72, v16, 0
  v_dot2_f32_bf16 v22, v73, v17, v22
  v_dot2_f32_bf16 v22, v74, v18, v22
  v_dot2_f32_bf16 v22, v75, v19, v22
  s_waitcnt vmcnt(3)
  buffer_load_dwordx4 v[168:171], v2, s[32:35], s83 offen offset:3072 nt
  v_dot2_f32_bf16 v23, v76, v16, 0
  v_dot2_f32_bf16 v23, v77, v17, v23
  v_dot2_f32_bf16 v23, v78, v18, v23
  v_dot2_f32_bf16 v23, v79, v19, v23
  s_nop 2
  v_permlane16_swap_b32 v22, v23
  v_add_f32 v22, v22, v23
  v_add_f32_dpp v26, v20, v20 row_ror:8 row_mask:0xf bank_mask:0x3
  s_nop 1
  v_add_f32_dpp v26, v22, v22 row_ror:8 row_mask:0xf bank_mask:0xc
  v_dot2_f32_bf16 v27, v92, v16, 0
  v_dot2_f32_bf16 v27, v93, v17, v27
  v_dot2_f32_bf16 v27, v94, v18, v27
  v_dot2_f32_bf16 v27, v95, v19, v27
  v_dot2_f32_bf16 v8, v96, v16, 0
  v_dot2_f32_bf16 v8, v97, v17, v8
  v_dot2_f32_bf16 v8, v98, v18, v8
  v_dot2_f32_bf16 v8, v99, v19, v8
  s_nop 2
  v_permlane16_swap_b32 v27, v8
  v_add_f32 v27, v27, v8
  s_waitcnt vmcnt(3)
  s_mov_b32 s83, 196608
  buffer_load_dwordx4 v[172:175], v2, s[32:35], s83 offen offset:0 nt
  v_dot2_f32_bf16 v9, v100, v16, 0
  v_dot2_f32_bf16 v9, v101, v17, v9
  v_dot2_f32_bf16 v9, v102, v18, v9
  v_dot2_f32_bf16 v9, v103, v19, v9
  v_dot2_f32_bf16 v10, v104, v16, 0
  v_dot2_f32_bf16 v10, v105, v17, v10
  v_dot2_f32_bf16 v10, v106, v18, v10
  v_dot2_f32_bf16 v10, v107, v19, v10
  s_nop 2
  v_permlane16_swap_b32 v9, v10
  v_add_f32 v9, v9, v10
  v_add_f32_dpp v11, v27, v27 row_ror:8 row_mask:0xf bank_mask:0x3
  s_nop 1
  v_add_f32_dpp v11, v9, v9 row_ror:8 row_mask:0xf bank_mask:0xc
  v_add_f32_dpp v12, v26, v26 row_shl:4 row_mask:0xf bank_mask:0x5
  s_nop 1
  v_add_f32_dpp v12, v11, v11 row_shr:4 row_mask:0xf bank_mask:0xa
  v_dot2_f32_bf16 v13, v108, v16, 0
  v_dot2_f32_bf16 v13, v109, v17, v13
  v_dot2_f32_bf16 v13, v110, v18, v13
  v_dot2_f32_bf16 v13, v111, v19, v13
  s_waitcnt vmcnt(3)
  buffer_load_dwordx4 v[176:179], v2, s[32:35], s83 offen offset:1024 nt
  v_dot2_f32_bf16 v21, v112, v16, 0
  v_dot2_f32_bf16 v21, v113, v17, v21
  v_dot2_f32_bf16 v21, v114, v18, v21
  v_dot2_f32_bf16 v21, v115, v19, v21
  s_nop 2
  v_permlane16_swap_b32 v13, v21
  v_add_f32 v13, v13, v21
  v_dot2_f32_bf16 v23, v116, v16, 0
  v_dot2_f32_bf16 v23, v117, v17, v23
  v_dot2_f32_bf16 v23, v118, v18, v23
  v_dot2_f32_bf16 v23, v119, v19, v23
  v_dot2_f32_bf16 v20, v120, v16, 0
  v_dot2_f32_bf16 v20, v121, v17, v20
  v_dot2_f32_bf16 v20, v122, v18, v20
  v_dot2_f32_bf16 v20, v123, v19, v20
  s_nop 2
  v_permlane16_swap_b32 v23, v20
  v_add_f32 v23, v23, v20
  v_add_f32_dpp v22, v13, v13 row_ror:8 row_mask:0xf bank_mask:0x3
  s_nop 1
  v_add_f32_dpp v22, v23, v23 row_ror:8 row_mask:0xf bank_mask:0xc
  s_waitcnt vmcnt(3)
  buffer_load_dwordx4 v[180:183], v2, s[32:35], s83 offen offset:2048 nt
  v_dot2_f32_bf16 v8, v124, v16, 0
  v_dot2_f32_bf16 v8, v125, v17, v8
  v_dot2_f32_bf16 v8, v126, v18, v8
  v_dot2_f32_bf16 v8, v127, v19, v8
  v_dot2_f32_bf16 v10, v128, v16, 0
  v_dot2_f32_bf16 v10, v129, v17, v10
  v_dot2_f32_bf16 v10, v130, v18, v10
  v_dot2_f32_bf16 v10, v131, v19, v10
  s_nop 2
  v_permlane16_swap_b32 v8, v10
  v_add_f32 v8, v8, v10
  v_dot2_f32_bf16 v27, v132, v16, 0
  v_dot2_f32_bf16 v27, v133, v17, v27
  v_dot2_f32_bf16 v27, v134, v18, v27
  v_dot2_f32_bf16 v27, v135, v19, v27
  s_waitcnt vmcnt(3)
  buffer_load_dwordx4 v[184:187], v2, s[32:35], s83 offen offset:3072 nt
  v_dot2_f32_bf16 v9, v136, v16, 0
  v_dot2_f32_bf16 v9, v137, v17, v9
  v_dot2_f32_bf16 v9, v138, v18, v9
  v_dot2_f32_bf16 v9, v139, v19, v9
  s_nop 2
  v_permlane16_swap_b32 v27, v9
  v_add_f32 v27, v27, v9
  v_add_f32_dpp v26, v8, v8 row_ror:8 row_mask:0xf bank_mask:0x3
  s_nop 1
  v_add_f32_dpp v26, v27, v27 row_ror:8 row_mask:0xf bank_mask:0xc
  v_add_f32_dpp v11, v22, v22 row_shl:4 row_mask:0xf bank_mask:0x5
  s_nop 1
  v_add_f32_dpp v11, v26, v26 row_shr:4 row_mask:0xf bank_mask:0xa
  v_add_f32_dpp v12, v12, v12 quad_perm:[2,3,0,1] row_mask:0xf bank_mask:0xf
  s_nop 0
  v_add_f32_dpp v11, v11, v11 quad_perm:[2,3,0,1] row_mask:0xf bank_mask:0xf
  v_cndmask_b32 v12, v12, v11, s[100:101]
  v_dot2_f32_bf16 v21, v140, v16, 0
  v_dot2_f32_bf16 v21, v141, v17, v21
  v_dot2_f32_bf16 v21, v142, v18, v21
  v_dot2_f32_bf16 v21, v143, v19, v21
  v_dot2_f32_bf16 v20, v144, v16, 0
  v_dot2_f32_bf16 v20, v145, v17, v20
  v_dot2_f32_bf16 v20, v146, v18, v20
  v_dot2_f32_bf16 v20, v147, v19, v20
  s_nop 2
  v_permlane16_swap_b32 v21, v20
  v_add_f32 v21, v21, v20
  s_waitcnt vmcnt(3)
  s_mov_b32 s83, 229376
  buffer_load_dwordx4 v[188:191], v2, s[32:35], s83 offen offset:0 nt
  v_dot2_f32_bf16 v13, v148, v16, 0
  v_dot2_f32_bf16 v13, v149, v17, v13
  v_dot2_f32_bf16 v13, v150, v18, v13
  v_dot2_f32_bf16 v13, v151, v19, v13
  v_dot2_f32_bf16 v23, v152, v16, 0
  v_dot2_f32_bf16 v23, v153, v17, v23
  v_dot2_f32_bf16 v23, v154, v18, v23
  v_dot2_f32_bf16 v23, v155, v19, v23
  s_nop 2
  v_permlane16_swap_b32 v13, v23
  v_add_f32 v13, v13, v23
  v_add_f32_dpp v10, v21, v21 row_ror:8 row_mask:0xf bank_mask:0x3
  s_nop 1
  v_add_f32_dpp v10, v13, v13 row_ror:8 row_mask:0xf bank_mask:0xc
  v_dot2_f32_bf16 v9, v156, v16, 0
  v_dot2_f32_bf16 v9, v157, v17, v9
  v_dot2_f32_bf16 v9, v158, v18, v9
  v_dot2_f32_bf16 v9, v159, v19, v9
  s_waitcnt vmcnt(3)
  buffer_load_dwordx4 v[192:195], v2, s[32:35], s83 offen offset:1024 nt
  v_dot2_f32_bf16 v8, v160, v16, 0
  v_dot2_f32_bf16 v8, v161, v17, v8
  v_dot2_f32_bf16 v8, v162, v18, v8
  v_dot2_f32_bf16 v8, v163, v19, v8
  s_nop 2
  v_permlane16_swap_b32 v9, v8
  v_add_f32 v9, v9, v8
  v_dot2_f32_bf16 v27, v164, v16, 0
  v_dot2_f32_bf16 v27, v165, v17, v27
  v_dot2_f32_bf16 v27, v166, v18, v27
  v_dot2_f32_bf16 v27, v167, v19, v27
  v_dot2_f32_bf16 v22, v168, v16, 0
  v_dot2_f32_bf16 v22, v169, v17, v22
  v_dot2_f32_bf16 v22, v170, v18, v22
  v_dot2_f32_bf16 v22, v171, v19, v22
  s_nop 2
  v_permlane16_swap_b32 v27, v22
  v_add_f32 v27, v27, v22
  v_add_f32_dpp v26, v9, v9 row_ror:8 row_mask:0xf bank_mask:0x3
  s_nop 1
  v_add_f32_dpp v26, v27, v27 row_ror:8 row_mask:0xf bank_mask:0xc
  v_add_f32_dpp v11, v10, v10 row_shl:4 row_mask:0xf bank_mask:0x5
  s_nop 1
  v_add_f32_dpp v11, v26, v26 row_shr:4 row_mask:0xf bank_mask:0xa
  s_waitcnt vmcnt(3)
  buffer_load_dwordx4 v[196:199], v2, s[32:35], s83 offen offset:2048 nt
  v_dot2_f32_bf16 v20, v172, v16, 0
  v_dot2_f32_bf16 v20, v173, v17, v20
  v_dot2_f32_bf16 v20, v174, v18, v20
  v_dot2_f32_bf16 v20, v175, v19, v20
  v_dot2_f32_bf16 v23, v176, v16, 0
  v_dot2_f32_bf16 v23, v177, v17, v23
  v_dot2_f32_bf16 v23, v178, v18, v23
  v_dot2_f32_bf16 v23, v179, v19, v23
  s_nop 2
  v_permlane16_swap_b32 v20, v23
  v_add_f32 v20, v20, v23
  v_dot2_f32_bf16 v21, v180, v16, 0
  v_dot2_f32_bf16 v21, v181, v17, v21
  v_dot2_f32_bf16 v21, v182, v18, v21
  v_dot2_f32_bf16 v21, v183, v19, v21
  s_waitcnt vmcnt(3)
  buffer_load_dwordx4 v[200:203], v2, s[32:35], s83 offen offset:3072 nt
  v_dot2_f32_bf16 v13, v184, v16, 0
  v_dot2_f32_bf16 v13, v185, v17, v13
  v_dot2_f32_bf16 v13, v186, v18, v13
  v_dot2_f32_bf16 v13, v187, v19, v13
  s_nop 2
  v_permlane16_swap_b32 v21, v13
  v_add_f32 v21, v21, v13
  v_add_f32_dpp v8, v20, v20 row_ror:8 row_mask:0xf bank_mask:0x3
  s_nop 1
  v_add_f32_dpp v8, v21, v21 row_ror:8 row_mask:0xf bank_mask:0xc
  s_waitcnt vmcnt(3)
  buffer_load_dwordx4 v[204:207], v2, s[36:39], 0 offen offset:0 nt
  v_dot2_f32_bf16 v22, v188, v16, 0
  v_dot2_f32_bf16 v22, v189, v17, v22
  v_dot2_f32_bf16 v22, v190, v18, v22
  v_dot2_f32_bf16 v22, v191, v19, v22
  s_waitcnt vmcnt(3)
  buffer_load_dwordx4 v[208:211], v2, s[36:39], 0 offen offset:1024 nt
  v_dot2_f32_bf16 v9, v192, v16, 0
  v_dot2_f32_bf16 v9, v193, v17, v9
  v_dot2_f32_bf16 v9, v194, v18, v9
  v_dot2_f32_bf16 v9, v195, v19, v9
  s_nop 2
  v_permlane16_swap_b32 v22, v9
  v_add_f32 v22, v22, v9
  s_waitcnt vmcnt(3)
  buffer_load_dwordx4 v[212:215], v2, s[36:39], 0 offen offset:2048 nt
  v_dot2_f32_bf16 v27, v196, v16, 0
  v_dot2_f32_bf16 v27, v197, v17, v27
  v_dot2_f32_bf16 v27, v198, v18, v27
  v_dot2_f32_bf16 v27, v199, v19, v27
  s_waitcnt vmcnt(3)
  buffer_load_dwordx4 v[216:219], v2, s[36:39], 0 offen offset:3072 nt
  v_dot2_f32_bf16 v10, v200, v16, 0
  v_dot2_f32_bf16 v10, v201, v17, v10
  v_dot2_f32_bf16 v10, v202, v18, v10
  v_dot2_f32_bf16 v10, v203, v19, v10
  s_nop 2
  v_permlane16_swap_b32 v27, v10
  v_add_f32 v27, v27, v10
  v_add_f32_dpp v26, v22, v22 row_ror:8 row_mask:0xf bank_mask:0x3
  s_nop 1
  v_add_f32_dpp v26, v27, v27 row_ror:8 row_mask:0xf bank_mask:0xc
  v_add_f32_dpp v23, v8, v8 row_shl:4 row_mask:0xf bank_mask:0x5
  s_nop 1
  v_add_f32_dpp v23, v26, v26 row_shr:4 row_mask:0xf bank_mask:0xa
  v_add_f32_dpp v11, v11, v11 quad_perm:[2,3,0,1] row_mask:0xf bank_mask:0xf
  s_nop 0
  v_add_f32_dpp v23, v23, v23 quad_perm:[2,3,0,1] row_mask:0xf bank_mask:0xf
  v_cndmask_b32 v11, v11, v23, s[100:101]
  v_add_f32_dpp v12, v12, v12 quad_perm:[1,0,3,2] row_mask:0xf bank_mask:0xf
  s_nop 0
  v_add_f32_dpp v11, v11, v11 quad_perm:[1,0,3,2] row_mask:0xf bank_mask:0xf
  v_cndmask_b32 v12, v12, v11, s[96:97]
  v_cvt_pk_bf16_f32 v12, v12, v12
  v_and_b32 v30, 0xffff0000, v12
  v_mov_b32 v20, v30
  s_nop 1
  v_max_f32_dpp v20, v20, v20 quad_perm:[1,0,3,2] row_mask:0xf bank_mask:0xf
  s_nop 1
  v_max_f32_dpp v20, v20, v20 quad_perm:[2,3,0,1] row_mask:0xf bank_mask:0xf
  s_nop 1
  v_max_f32_dpp v20, v20, v20 row_half_mirror row_mask:0xf bank_mask:0xf
  s_nop 1
  v_max_f32_dpp v20, v20, v20 row_mirror row_mask:0xf bank_mask:0xf
  s_nop 1
  v_max_f32_dpp v20, v20, v20 row_bcast:15 row_mask:0xa bank_mask:0xf
  s_nop 1
  v_max_f32_dpp v20, v20, v20 row_bcast:31 row_mask:0xc bank_mask:0xf
  s_nop 0
  v_readlane_b32 s81, v20, 63
  v_bfrev_b32 v22, v1
  v_bfe_u32 v22, v22, 27, 5
  v_mov_b32 v34, s81
  v_lshlrev_b32 v22, 2, v22
  s_lshl_b32 s81, s3, 8
  v_lshl_add_u32 v23, v6, 7, s81
  v_add_u32 v22, v22, v23
  v_sub_f32 v20, v30, v34
  v_mul_f32 v20, 0x3db8aa3b, v20
  v_exp_f32 v20, v20
  s_nop 0
  ds_write_b32 v22, v20 offset:1024
  v_mov_b32 v21, v20
  ds_read_b128 v[16:19], v23 offset:1024
  s_waitcnt vmcnt(3)
  s_mov_b32 s83, 32768
  buffer_load_dwordx4 v[220:223], v2, s[36:39], s83 offen offset:0 nt
  v_add_f32_dpp v21, v21, v21 quad_perm:[1,0,3,2] row_mask:0xf bank_mask:0xf
  s_nop 1
  v_add_f32_dpp v21, v21, v21 quad_perm:[2,3,0,1] row_mask:0xf bank_mask:0xf
  s_nop 1
  v_add_f32_dpp v21, v21, v21 row_half_mirror row_mask:0xf bank_mask:0xf
  s_nop 1
  v_add_f32_dpp v21, v21, v21 row_mirror row_mask:0xf bank_mask:0xf
  s_nop 1
  v_add_f32_dpp v21, v21, v21 row_bcast:15 row_mask:0xa bank_mask:0xf
  s_nop 1
  v_add_f32_dpp v21, v21, v21 row_bcast:31 row_mask:0xc bank_mask:0xf
  s_nop 0
  v_readlane_b32 s81, v21, 63
  v_mov_b32 v40, v34
  v_mov_b32 v21, 0
  v_mov_b32 v41, s81
  v_mov_b32 v20, 1
  s_getreg_b32 s86, hwreg(HW_REG_XCC_ID)
  s_and_b32 s86, s86, 15
  s_mov_b64 exec, 1
  ds_write_b64 v31, v[40:41] offset:512
  ds_add_rtn_u32 v20, v21, v20 offset:576
  s_mov_b64 exec, -1
  s_waitcnt vmcnt(3)
  buffer_load_dwordx4 v[224:227], v2, s[36:39], s83 offen offset:1024 nt
  s_waitcnt lgkmcnt(0)
  v_readfirstlane_b32 s81, v20
  s_nop 0
  s_cmp_lg_u32 s81, 7
  s_cbranch_scc1 L_noml
  v_and_b32 v22, 7, v1
  v_lshlrev_b32 v22, 3, v22
  ds_read_b64 v[40:41], v22 offset:512
  v_cmp_gt_u32 vcc, 2, v1
  v_mov_b32 v22, 0x80000000
  s_nop 0
  v_cndmask_b32 v22, v22, v7, vcc
  v_mov_b32 v20, s86
  s_lshl_b32 s81, s80, 7
  s_add_u32 s81, s81, 32768
  s_waitcnt lgkmcnt(0)
  v_mov_b32 v43, v40
  s_nop 1
  v_max_f32_dpp v43, v43, v43 quad_perm:[1,0,3,2] row_mask:0xf bank_mask:0xf
  s_nop 1
  v_max_f32_dpp v43, v43, v43 quad_perm:[2,3,0,1] row_mask:0xf bank_mask:0xf
  s_nop 1
  v_max_f32_dpp v43, v43, v43 row_half_mirror row_mask:0xf bank_mask:0xf
  v_sub_f32 v40, v40, v43
  v_mul_f32 v40, 0x3db8aa3b, v40
  v_exp_f32 v40, v40
  s_nop 0
  v_mul_f32 v42, v41, v40
  s_nop 1
  v_add_f32_dpp v42, v42, v42 quad_perm:[1,0,3,2] row_mask:0xf bank_mask:0xf
  s_nop 1
  v_add_f32_dpp v42, v42, v42 quad_perm:[2,3,0,1] row_mask:0xf bank_mask:0xf
  s_nop 1
  v_add_f32_dpp v42, v42, v42 row_half_mirror row_mask:0xf bank_mask:0xf
  v_cndmask_b32 v40, v43, v20, s[96:97]
  v_mov_b32 v41, v32
  v_mov_b32 v43, v32
  buffer_store_dwordx4 v[40:43], v22, s[56:59], s81 offen sc1
L_noml:
  s_nop 4
  ds_read_b128 v[24:27], v23 offset:1040
  v_lshlrev_b32 v20, 16, v204
  v_and_b32 v21, 0xffff0000, v204
  v_mul_f32 v8, v20, v16
  v_mul_f32 v9, v21, v16
  v_lshlrev_b32 v20, 16, v205
  v_and_b32 v21, 0xffff0000, v205
  v_mul_f32 v10, v20, v16
  v_mul_f32 v11, v21, v16
  v_lshlrev_b32 v20, 16, v206
  v_and_b32 v21, 0xffff0000, v206
  v_mul_f32 v12, v20, v16
  v_mul_f32 v13, v21, v16
  v_lshlrev_b32 v20, 16, v207
  v_and_b32 v21, 0xffff0000, v207
  v_mul_f32 v14, v20, v16
  v_mul_f32 v15, v21, v16
  v_lshlrev_b32 v20, 16, v208
  v_and_b32 v21, 0xffff0000, v208
  v_fmac_f32 v8, v20, v17
  v_fmac_f32 v9, v21, v17
  v_lshlrev_b32 v20, 16, v209
  v_and_b32 v21, 0xffff0000, v209
  v_fmac_f32 v10, v20, v17
  v_fmac_f32 v11, v21, v17
  v_lshlrev_b32 v20, 16, v210
  v_and_b32 v21, 0xffff0000, v210
  v_fmac_f32 v12, v20, v17
  v_fmac_f32 v13, v21, v17
  v_lshlrev_b32 v20, 16, v211
  v_and_b32 v21, 0xffff0000, v211
  v_fmac_f32 v14, v20, v17
  v_fmac_f32 v15, v21, v17
  s_waitcnt vmcnt(3)
  buffer_load_dwordx4 v[228:231], v2, s[36:39], s83 offen offset:2048 nt
  v_lshlrev_b32 v20, 16, v212
  v_and_b32 v21, 0xffff0000, v212
  v_fmac_f32 v8, v20, v18
  v_fmac_f32 v9, v21, v18
  v_lshlrev_b32 v20, 16, v213
  v_and_b32 v21, 0xffff0000, v213
  v_fmac_f32 v10, v20, v18
  v_fmac_f32 v11, v21, v18
  v_lshlrev_b32 v20, 16, v214
  v_and_b32 v21, 0xffff0000, v214
  v_fmac_f32 v12, v20, v18
  v_fmac_f32 v13, v21, v18
  v_lshlrev_b32 v20, 16, v215
  v_and_b32 v21, 0xffff0000, v215
  v_fmac_f32 v14, v20, v18
  v_fmac_f32 v15, v21, v18
  s_waitcnt vmcnt(3)
  buffer_load_dwordx4 v[232:235], v2, s[36:39], s83 offen offset:3072 nt
  v_lshlrev_b32 v20, 16, v216
  v_and_b32 v21, 0xffff0000, v216
  v_fmac_f32 v8, v20, v19
  v_fmac_f32 v9, v21, v19
  v_lshlrev_b32 v20, 16, v217
  v_and_b32 v21, 0xffff0000, v217
  v_fmac_f32 v10, v20, v19
  v_fmac_f32 v11, v21, v19
  v_lshlrev_b32 v20, 16, v218
  v_and_b32 v21, 0xffff0000, v218
  v_fmac_f32 v12, v20, v19
  v_fmac_f32 v13, v21, v19
  v_lshlrev_b32 v20, 16, v219
  v_and_b32 v21, 0xffff0000, v219
  v_fmac_f32 v14, v20, v19
  v_fmac_f32 v15, v21, v19
  s_waitcnt vmcnt(3)
  s_mov_b32 s83, 65536
  buffer_load_dwordx4 v[80:83], v2, s[36:39], s83 offen offset:0 nt
  ds_read_b128 v[16:19], v23 offset:1056
  s_waitcnt lgkmcnt(1)
  v_lshlrev_b32 v20, 16, v220
  v_and_b32 v21, 0xffff0000, v220
  v_fmac_f32 v8, v20, v24
  v_fmac_f32 v9, v21, v24
  v_lshlrev_b32 v20, 16, v221
  v_and_b32 v21, 0xffff0000, v221
  v_fmac_f32 v10, v20, v24
  v_fmac_f32 v11, v21, v24
  v_lshlrev_b32 v20, 16, v222
  v_and_b32 v21, 0xffff0000, v222
  v_fmac_f32 v12, v20, v24
  v_fmac_f32 v13, v21, v24
  v_lshlrev_b32 v20, 16, v223
  v_and_b32 v21, 0xffff0000, v223
  v_fmac_f32 v14, v20, v24
  v_fmac_f32 v15, v21, v24
  s_waitcnt vmcnt(3)
  buffer_load_dwordx4 v[84:87], v2, s[36:39], s83 offen offset:1024 nt
  v_lshlrev_b32 v20, 16, v224
  v_and_b32 v21, 0xffff0000, v224
  v_fmac_f32 v8, v20, v25
  v_fmac_f32 v9, v21, v25
  v_lshlrev_b32 v20, 16, v225
  v_and_b32 v21, 0xffff0000, v225
  v_fmac_f32 v10, v20, v25
  v_fmac_f32 v11, v21, v25
  v_lshlrev_b32 v20, 16, v226
  v_and_b32 v21, 0xffff0000, v226
  v_fmac_f32 v12, v20, v25
  v_fmac_f32 v13, v21, v25
  v_lshlrev_b32 v20, 16, v227
  v_and_b32 v21, 0xffff0000, v227
  v_fmac_f32 v14, v20, v25
  v_fmac_f32 v15, v21, v25
  s_mov_b32 s94, 114688
  buffer_load_ushort v35, v35, s[12:15], 0 offen
  buffer_load_dwordx4 v[44:47], v63, s[56:59], 0 offen sc1
  buffer_load_dwordx4 v[48:51], v63, s[56:59], s94 offen sc1
  s_waitcnt vmcnt(6)
  buffer_load_dwordx4 v[88:91], v2, s[36:39], s83 offen offset:2048 nt
  v_lshlrev_b32 v20, 16, v228
  v_and_b32 v21, 0xffff0000, v228
  v_fmac_f32 v8, v20, v26
  v_fmac_f32 v9, v21, v26
  v_lshlrev_b32 v20, 16, v229
  v_and_b32 v21, 0xffff0000, v229
  v_fmac_f32 v10, v20, v26
  v_fmac_f32 v11, v21, v26
  v_lshlrev_b32 v20, 16, v230
  v_and_b32 v21, 0xffff0000, v230
  v_fmac_f32 v12, v20, v26
  v_fmac_f32 v13, v21, v26
  v_lshlrev_b32 v20, 16, v231
  v_and_b32 v21, 0xffff0000, v231
  v_fmac_f32 v14, v20, v26
  v_fmac_f32 v15, v21, v26
  s_waitcnt vmcnt(6)
  buffer_load_dwordx4 v[64:67], v2, s[36:39], s83 offen offset:3072 nt
  v_lshlrev_b32 v20, 16, v232
  v_and_b32 v21, 0xffff0000, v232
  v_fmac_f32 v8, v20, v27
  v_fmac_f32 v9, v21, v27
  v_lshlrev_b32 v20, 16, v233
  v_and_b32 v21, 0xffff0000, v233
  v_fmac_f32 v10, v20, v27
  v_fmac_f32 v11, v21, v27
  v_lshlrev_b32 v20, 16, v234
  v_and_b32 v21, 0xffff0000, v234
  v_fmac_f32 v12, v20, v27
  v_fmac_f32 v13, v21, v27
  v_lshlrev_b32 v20, 16, v235
  v_and_b32 v21, 0xffff0000, v235
  v_fmac_f32 v14, v20, v27
  v_fmac_f32 v15, v21, v27
  s_waitcnt vmcnt(6)
  s_mov_b32 s83, 98304
  buffer_load_dwordx4 v[68:71], v2, s[36:39], s83 offen offset:0 nt
  ds_read_b128 v[24:27], v23 offset:1072
  s_waitcnt lgkmcnt(1)
  v_lshlrev_b32 v20, 16, v80
  v_and_b32 v21, 0xffff0000, v80
  v_fmac_f32 v8, v20, v16
  v_fmac_f32 v9, v21, v16
  v_lshlrev_b32 v20, 16, v81
  v_and_b32 v21, 0xffff0000, v81
  v_fmac_f32 v10, v20, v16
  v_fmac_f32 v11, v21, v16
  v_lshlrev_b32 v20, 16, v82
  v_and_b32 v21, 0xffff0000, v82
  v_fmac_f32 v12, v20, v16
  v_fmac_f32 v13, v21, v16
  v_lshlrev_b32 v20, 16, v83
  v_and_b32 v21, 0xffff0000, v83
  v_fmac_f32 v14, v20, v16
  v_fmac_f32 v15, v21, v16
  s_waitcnt vmcnt(6)
  buffer_load_dwordx4 v[72:75], v2, s[36:39], s83 offen offset:1024 nt
  v_lshlrev_b32 v20, 16, v84
  v_and_b32 v21, 0xffff0000, v84
  v_fmac_f32 v8, v20, v17
  v_fmac_f32 v9, v21, v17
  v_lshlrev_b32 v20, 16, v85
  v_and_b32 v21, 0xffff0000, v85
  v_fmac_f32 v10, v20, v17
  v_fmac_f32 v11, v21, v17
  v_lshlrev_b32 v20, 16, v86
  v_and_b32 v21, 0xffff0000, v86
  v_fmac_f32 v12, v20, v17
  v_fmac_f32 v13, v21, v17
  v_lshlrev_b32 v20, 16, v87
  v_and_b32 v21, 0xffff0000, v87
  v_fmac_f32 v14, v20, v17
  v_fmac_f32 v15, v21, v17
  s_waitcnt vmcnt(3)
  buffer_load_dwordx4 v[76:79], v2, s[36:39], s83 offen offset:2048 nt
  v_lshlrev_b32 v20, 16, v88
  v_and_b32 v21, 0xffff0000, v88
  v_fmac_f32 v8, v20, v18
  v_fmac_f32 v9, v21, v18
  v_lshlrev_b32 v20, 16, v89
  v_and_b32 v21, 0xffff0000, v89
  v_fmac_f32 v10, v20, v18
  v_fmac_f32 v11, v21, v18
  v_lshlrev_b32 v20, 16, v90
  v_and_b32 v21, 0xffff0000, v90
  v_fmac_f32 v12, v20, v18
  v_fmac_f32 v13, v21, v18
  v_lshlrev_b32 v20, 16, v91
  v_and_b32 v21, 0xffff0000, v91
  v_fmac_f32 v14, v20, v18
  v_fmac_f32 v15, v21, v18
  s_cmp_ge_u32 s79, 14
  s_cbranch_scc1 L_hok
  s_cmp_eq_u32 s3, 7
  s_cbranch_scc1 L_hok
  s_mov_b32 s91, 131072
L_hchk:
  s_nop 4
  v_cmp_ne_u32 vcc, v45, v32
  v_cmp_ne_u32 s[98:99], v47, v32
  s_nop 0
  s_or_b64 vcc, vcc, s[98:99]
  v_cmp_ne_u32 s[98:99], v49, v32
  s_nop 0
  s_or_b64 vcc, vcc, s[98:99]
  v_cmp_ne_u32 s[98:99], v51, v32
  s_nop 0
  s_or_b64 vcc, vcc, s[98:99]
  s_cmp_lg_u64 vcc, 0
  s_cbranch_scc0 L_hok
  s_sub_u32 s91, s91, 1
  s_cbranch_scc1 L_hok
  s_sleep 2
  buffer_load_dwordx4 v[44:47], v63, s[56:59], 0 offen sc1
  buffer_load_dwordx4 v[48:51], v63, s[56:59], s94 offen sc1
  s_waitcnt vmcnt(0)
  s_branch L_hchk
L_hok:
  s_nop 4
  v_lshlrev_b32 v35, 16, v35
  v_cndmask_b32 v20, v44, v46, s[96:97]
  v_cndmask_b32 v48, v48, v50, s[96:97]
  s_nop 1
  v_permlane16_swap_b32 v20, v48
  v_add_f32 v20, v20, v48
  s_nop 1
  v_add_f32_dpp v20, v20, v20 row_ror:8 row_mask:0xf bank_mask:0xf
  v_mov_b32 v48, v20
  s_nop 1
  v_permlane32_swap_b32 v20, v48
  v_add_f32 v20, v20, v48
  v_mov_b32 v48, v20
  s_nop 1
  v_permlane16_swap_b32 v20, v48
  v_cvt_pk_bf16_f32 v20, v20, v48
  v_lshlrev_b32 v21, 16, v20
  v_and_b32 v22, 0xffff0000, v20
  v_add_f32 v21, v35, v21
  v_add_f32 v22, v35, v22
  v_cvt_pk_bf16_f32 v20, v21, v22
  v_lshlrev_b32 v21, 16, v20
  v_and_b32 v22, 0xffff0000, v20
  v_max_f32 v21, 0, v21
  v_max_f32 v22, 0, v22
  v_mul_f32 v21, v21, v21
  v_mul_f32 v22, v22, v22
  v_cvt_pk_bf16_f32 v44, v21, v22
  v_lshrrev_b32 v45, 3, v1
  v_lshlrev_b32 v45, 2, v45
  ds_bpermute_b32 v35, v45, v44
  s_cmp_eq_u32 s95, 0
  s_cbranch_scc1 L_nog
  buffer_load_dwordx4 v[92:95], v56, s[60:63], s92 offen
  buffer_load_dwordx4 v[96:99], v56, s[64:67], 0 offen
  buffer_load_ushort v33, v33, s[68:71], s93 offen
L_nog:
  s_waitcnt vmcnt(3)
  buffer_load_dwordx4 v[100:103], v2, s[36:39], s83 offen offset:3072 nt
  v_lshlrev_b32 v20, 16, v64
  v_and_b32 v21, 0xffff0000, v64
  v_fmac_f32 v8, v20, v19
  v_fmac_f32 v9, v21, v19
  v_lshlrev_b32 v20, 16, v65
  v_and_b32 v21, 0xffff0000, v65
  v_fmac_f32 v10, v20, v19
  v_fmac_f32 v11, v21, v19
  v_lshlrev_b32 v20, 16, v66
  v_and_b32 v21, 0xffff0000, v66
  v_fmac_f32 v12, v20, v19
  v_fmac_f32 v13, v21, v19
  v_lshlrev_b32 v20, 16, v67
  v_and_b32 v21, 0xffff0000, v67
  v_fmac_f32 v14, v20, v19
  v_fmac_f32 v15, v21, v19
  s_waitcnt vmcnt(3)
  s_mov_b32 s83, 131072
  buffer_load_dwordx4 v[104:107], v2, s[36:39], s83 offen offset:0 nt
  ds_read_b128 v[16:19], v23 offset:1088
  s_waitcnt lgkmcnt(2)
  v_lshlrev_b32 v20, 16, v68
  v_and_b32 v21, 0xffff0000, v68
  v_fmac_f32 v8, v20, v24
  v_fmac_f32 v9, v21, v24
  v_lshlrev_b32 v20, 16, v69
  v_and_b32 v21, 0xffff0000, v69
  v_fmac_f32 v10, v20, v24
  v_fmac_f32 v11, v21, v24
  v_lshlrev_b32 v20, 16, v70
  v_and_b32 v21, 0xffff0000, v70
  v_fmac_f32 v12, v20, v24
  v_fmac_f32 v13, v21, v24
  v_lshlrev_b32 v20, 16, v71
  v_and_b32 v21, 0xffff0000, v71
  v_fmac_f32 v14, v20, v24
  v_fmac_f32 v15, v21, v24
  s_waitcnt vmcnt(3)
  buffer_load_dwordx4 v[108:111], v2, s[36:39], s83 offen offset:1024 nt
  v_lshlrev_b32 v20, 16, v72
  v_and_b32 v21, 0xffff0000, v72
  v_fmac_f32 v8, v20, v25
  v_fmac_f32 v9, v21, v25
  v_lshlrev_b32 v20, 16, v73
  v_and_b32 v21, 0xffff0000, v73
  v_fmac_f32 v10, v20, v25
  v_fmac_f32 v11, v21, v25
  v_lshlrev_b32 v20, 16, v74
  v_and_b32 v21, 0xffff0000, v74
  v_fmac_f32 v12, v20, v25
  v_fmac_f32 v13, v21, v25
  v_lshlrev_b32 v20, 16, v75
  v_and_b32 v21, 0xffff0000, v75
  v_fmac_f32 v14, v20, v25
  v_fmac_f32 v15, v21, v25
  s_waitcnt vmcnt(3)
  buffer_load_dwordx4 v[112:115], v2, s[36:39], s83 offen offset:2048 nt
  v_lshlrev_b32 v20, 16, v76
  v_and_b32 v21, 0xffff0000, v76
  v_fmac_f32 v8, v20, v26
  v_fmac_f32 v9, v21, v26
  v_lshlrev_b32 v20, 16, v77
  v_and_b32 v21, 0xffff0000, v77
  v_fmac_f32 v10, v20, v26
  v_fmac_f32 v11, v21, v26
  v_lshlrev_b32 v20, 16, v78
  v_and_b32 v21, 0xffff0000, v78
  v_fmac_f32 v12, v20, v26
  v_fmac_f32 v13, v21, v26
  v_lshlrev_b32 v20, 16, v79
  v_and_b32 v21, 0xffff0000, v79
  v_fmac_f32 v14, v20, v26
  v_fmac_f32 v15, v21, v26
  s_waitcnt vmcnt(3)
  buffer_load_dwordx4 v[116:119], v2, s[36:39], s83 offen offset:3072 nt
  v_lshlrev_b32 v20, 16, v100
  v_and_b32 v21, 0xffff0000, v100
  v_fmac_f32 v8, v20, v27
  v_fmac_f32 v9, v21, v27
  v_lshlrev_b32 v20, 16, v101
  v_and_b32 v21, 0xffff0000, v101
  v_fmac_f32 v10, v20, v27
  v_fmac_f32 v11, v21, v27
  v_lshlrev_b32 v20, 16, v102
  v_and_b32 v21, 0xffff0000, v102
  v_fmac_f32 v12, v20, v27
  v_fmac_f32 v13, v21, v27
  v_lshlrev_b32 v20, 16, v103
  v_and_b32 v21, 0xffff0000, v103
  v_fmac_f32 v14, v20, v27
  v_fmac_f32 v15, v21, v27
  v_lshrrev_b32 v30, 4, v1
  v_xor_b32 v30, s77, v30
  v_lshlrev_b32 v30, 14, v30
  v_bfe_u32 v22, v1, 1, 3
  v_lshl_add_u32 v30, v22, 7, v30
  v_and_b32 v22, 1, v1
  v_lshl_add_u32 v30, v22, 4, v30
  v_cmp_gt_u32 vcc, 32, v1
  v_mov_b32 v22, 0x80000000
  s_nop 0
  v_cndmask_b32 v22, v22, v30, vcc
  s_lshl_b32 s94, s76, 10
  s_add_u32 s94, s94, 32768
  buffer_load_dwordx4 v[36:39], v22, s[56:59], s94 offen sc1
  s_waitcnt vmcnt(4)
  s_mov_b32 s83, 163840
  buffer_load_dwordx4 v[120:123], v2, s[36:39], s83 offen offset:0 nt
  ds_read_b128 v[24:27], v23 offset:1104
  s_waitcnt lgkmcnt(1)
  v_lshlrev_b32 v20, 16, v104
  v_and_b32 v21, 0xffff0000, v104
  v_fmac_f32 v8, v20, v16
  v_fmac_f32 v9, v21, v16
  v_lshlrev_b32 v20, 16, v105
  v_and_b32 v21, 0xffff0000, v105
  v_fmac_f32 v10, v20, v16
  v_fmac_f32 v11, v21, v16
  v_lshlrev_b32 v20, 16, v106
  v_and_b32 v21, 0xffff0000, v106
  v_fmac_f32 v12, v20, v16
  v_fmac_f32 v13, v21, v16
  v_lshlrev_b32 v20, 16, v107
  v_and_b32 v21, 0xffff0000, v107
  v_fmac_f32 v14, v20, v16
  v_fmac_f32 v15, v21, v16
  s_waitcnt vmcnt(4)
  buffer_load_dwordx4 v[124:127], v2, s[36:39], s83 offen offset:1024 nt
  v_lshlrev_b32 v20, 16, v108
  v_and_b32 v21, 0xffff0000, v108
  v_fmac_f32 v8, v20, v17
  v_fmac_f32 v9, v21, v17
  v_lshlrev_b32 v20, 16, v109
  v_and_b32 v21, 0xffff0000, v109
  v_fmac_f32 v10, v20, v17
  v_fmac_f32 v11, v21, v17
  v_lshlrev_b32 v20, 16, v110
  v_and_b32 v21, 0xffff0000, v110
  v_fmac_f32 v12, v20, v17
  v_fmac_f32 v13, v21, v17
  v_lshlrev_b32 v20, 16, v111
  v_and_b32 v21, 0xffff0000, v111
  v_fmac_f32 v14, v20, v17
  v_fmac_f32 v15, v21, v17
  s_waitcnt vmcnt(4)
  buffer_load_dwordx4 v[128:131], v2, s[36:39], s83 offen offset:2048 nt
  v_lshlrev_b32 v20, 16, v112
  v_and_b32 v21, 0xffff0000, v112
  v_fmac_f32 v8, v20, v18
  v_fmac_f32 v9, v21, v18
  v_lshlrev_b32 v20, 16, v113
  v_and_b32 v21, 0xffff0000, v113
  v_fmac_f32 v10, v20, v18
  v_fmac_f32 v11, v21, v18
  v_lshlrev_b32 v20, 16, v114
  v_and_b32 v21, 0xffff0000, v114
  v_fmac_f32 v12, v20, v18
  v_fmac_f32 v13, v21, v18
  v_lshlrev_b32 v20, 16, v115
  v_and_b32 v21, 0xffff0000, v115
  v_fmac_f32 v14, v20, v18
  v_fmac_f32 v15, v21, v18
  s_waitcnt vmcnt(4)
  buffer_load_dwordx4 v[132:135], v2, s[36:39], s83 offen offset:3072 nt
  v_lshlrev_b32 v20, 16, v116
  v_and_b32 v21, 0xffff0000, v116
  v_fmac_f32 v8, v20, v19
  v_fmac_f32 v9, v21, v19
  v_lshlrev_b32 v20, 16, v117
  v_and_b32 v21, 0xffff0000, v117
  v_fmac_f32 v10, v20, v19
  v_fmac_f32 v11, v21, v19
  v_lshlrev_b32 v20, 16, v118
  v_and_b32 v21, 0xffff0000, v118
  v_fmac_f32 v12, v20, v19
  v_fmac_f32 v13, v21, v19
  v_lshlrev_b32 v20, 16, v119
  v_and_b32 v21, 0xffff0000, v119
  v_fmac_f32 v14, v20, v19
  v_fmac_f32 v15, v21, v19
  s_waitcnt vmcnt(3)
  s_mov_b32 s83, 196608
  buffer_load_dwordx4 v[136:139], v2, s[36:39], s83 offen offset:0 nt
  ds_read_b128 v[16:19], v23 offset:1120
  s_waitcnt lgkmcnt(1)
  v_lshlrev_b32 v20, 16, v120
  v_and_b32 v21, 0xffff0000, v120
  v_fmac_f32 v8, v20, v24
  v_fmac_f32 v9, v21, v24
  v_lshlrev_b32 v20, 16, v121
  v_and_b32 v21, 0xffff0000, v121
  v_fmac_f32 v10, v20, v24
  v_fmac_f32 v11, v21, v24
  v_lshlrev_b32 v20, 16, v122
  v_and_b32 v21, 0xffff0000, v122
  v_fmac_f32 v12, v20, v24
  v_fmac_f32 v13, v21, v24
  v_lshlrev_b32 v20, 16, v123
  v_and_b32 v21, 0xffff0000, v123
  v_fmac_f32 v14, v20, v24
  v_fmac_f32 v15, v21, v24
  s_mov_b32 s91, 131072
L_mlchk:
  s_nop 4
  v_cmp_ne_u32 vcc, v37, v32
  v_cmp_ne_u32 s[98:99], v39, v32
  s_nop 0
  s_or_b64 vcc, vcc, s[98:99]
  s_cmp_lg_u32 vcc_lo, 0
  s_cbranch_scc0 L_mlok
  s_sub_u32 s91, s91, 1
  s_cbranch_scc1 L_mlok
  s_sleep 2
  buffer_load_dwordx4 v[36:39], v22, s[56:59], s94 offen sc1
  s_waitcnt vmcnt(0)
  s_branch L_mlchk
L_mlok:
  s_nop 4
  v_cmp_ne_u32 vcc, s86, v36
  v_mov_b32 v37, v36
  s_and_b32 s86, vcc_lo, 0xaaaaaaaa
  s_nop 0
  v_max_f32_dpp v37, v37, v37 quad_perm:[2,3,0,1] row_mask:0xf bank_mask:0xf
  s_nop 1
  v_max_f32_dpp v37, v37, v37 row_ror:4 row_mask:0xf bank_mask:0xf
  s_nop 1
  v_max_f32_dpp v37, v37, v37 row_ror:8 row_mask:0xf bank_mask:0xf
  v_sub_f32 v36, v36, v37
  v_sub_f32 v39, v34, v37
  v_mul_f32 v36, 0x3db8aa3b, v36
  v_mul_f32 v39, 0x3db8aa3b, v39
  v_exp_f32 v36, v36
  v_exp_f32 v39, v39
  v_mul_f32 v38, v38, v36
  s_nop 1
  v_add_f32_dpp v38, v38, v38 quad_perm:[2,3,0,1] row_mask:0xf bank_mask:0xf
  s_nop 1
  v_add_f32_dpp v38, v38, v38 row_ror:4 row_mask:0xf bank_mask:0xf
  s_nop 1
  v_add_f32_dpp v38, v38, v38 row_ror:8 row_mask:0xf bank_mask:0xf
  v_rcp_f32 v38, v38
  s_nop 0
  v_mul_f32 v38, v38, v39
  s_nop 0
  v_readfirstlane_b32 s94, v38
  v_and_b32 v44, 0xffff, v35
  v_lshlrev_b32 v45, 16, v35
  v_lshrrev_b32 v46, 16, v35
  v_and_b32 v47, 0xffff0000, v35
  s_waitcnt vmcnt(3)
  buffer_load_dwordx4 v[140:143], v2, s[36:39], s83 offen offset:1024 nt
  v_lshlrev_b32 v20, 16, v124
  v_and_b32 v21, 0xffff0000, v124
  v_fmac_f32 v8, v20, v25
  v_fmac_f32 v9, v21, v25
  v_lshlrev_b32 v20, 16, v125
  v_and_b32 v21, 0xffff0000, v125
  v_fmac_f32 v10, v20, v25
  v_fmac_f32 v11, v21, v25
  v_lshlrev_b32 v20, 16, v126
  v_and_b32 v21, 0xffff0000, v126
  v_fmac_f32 v12, v20, v25
  v_fmac_f32 v13, v21, v25
  v_lshlrev_b32 v20, 16, v127
  v_and_b32 v21, 0xffff0000, v127
  v_fmac_f32 v14, v20, v25
  v_fmac_f32 v15, v21, v25
  s_waitcnt vmcnt(3)
  buffer_load_dwordx4 v[144:147], v2, s[36:39], s83 offen offset:2048 nt
  v_lshlrev_b32 v20, 16, v128
  v_and_b32 v21, 0xffff0000, v128
  v_fmac_f32 v8, v20, v26
  v_fmac_f32 v9, v21, v26
  v_lshlrev_b32 v20, 16, v129
  v_and_b32 v21, 0xffff0000, v129
  v_fmac_f32 v10, v20, v26
  v_fmac_f32 v11, v21, v26
  v_lshlrev_b32 v20, 16, v130
  v_and_b32 v21, 0xffff0000, v130
  v_fmac_f32 v12, v20, v26
  v_fmac_f32 v13, v21, v26
  v_lshlrev_b32 v20, 16, v131
  v_and_b32 v21, 0xffff0000, v131
  v_fmac_f32 v14, v20, v26
  v_fmac_f32 v15, v21, v26
  s_waitcnt vmcnt(3)
  buffer_load_dwordx4 v[148:151], v2, s[36:39], s83 offen offset:3072 nt
  v_lshlrev_b32 v20, 16, v132
  v_and_b32 v21, 0xffff0000, v132
  v_fmac_f32 v8, v20, v27
  v_fmac_f32 v9, v21, v27
  v_lshlrev_b32 v20, 16, v133
  v_and_b32 v21, 0xffff0000, v133
  v_fmac_f32 v10, v20, v27
  v_fmac_f32 v11, v21, v27
  v_lshlrev_b32 v20, 16, v134
  v_and_b32 v21, 0xffff0000, v134
  v_fmac_f32 v12, v20, v27
  v_fmac_f32 v13, v21, v27
  v_lshlrev_b32 v20, 16, v135
  v_and_b32 v21, 0xffff0000, v135
  v_fmac_f32 v14, v20, v27
  v_fmac_f32 v15, v21, v27
  s_waitcnt vmcnt(3)
  s_mov_b32 s83, 229376
  buffer_load_dwordx4 v[152:155], v2, s[36:39], s83 offen offset:0 nt
  ds_read_b128 v[24:27], v23 offset:1136
  s_waitcnt lgkmcnt(1)
  v_lshlrev_b32 v20, 16, v136
  v_and_b32 v21, 0xffff0000, v136
  v_fmac_f32 v8, v20, v16
  v_fmac_f32 v9, v21, v16
  v_lshlrev_b32 v20, 16, v137
  v_and_b32 v21, 0xffff0000, v137
  v_fmac_f32 v10, v20, v16
  v_fmac_f32 v11, v21, v16
  v_lshlrev_b32 v20, 16, v138
  v_and_b32 v21, 0xffff0000, v138
  v_fmac_f32 v12, v20, v16
  v_fmac_f32 v13, v21, v16
  v_lshlrev_b32 v20, 16, v139
  v_and_b32 v21, 0xffff0000, v139
  v_fmac_f32 v14, v20, v16
  v_fmac_f32 v15, v21, v16
  s_waitcnt vmcnt(3)
  buffer_load_dwordx4 v[156:159], v2, s[36:39], s83 offen offset:1024 nt
  v_lshlrev_b32 v20, 16, v140
  v_and_b32 v21, 0xffff0000, v140
  v_fmac_f32 v8, v20, v17
  v_fmac_f32 v9, v21, v17
  v_lshlrev_b32 v20, 16, v141
  v_and_b32 v21, 0xffff0000, v141
  v_fmac_f32 v10, v20, v17
  v_fmac_f32 v11, v21, v17
  v_lshlrev_b32 v20, 16, v142
  v_and_b32 v21, 0xffff0000, v142
  v_fmac_f32 v12, v20, v17
  v_fmac_f32 v13, v21, v17
  v_lshlrev_b32 v20, 16, v143
  v_and_b32 v21, 0xffff0000, v143
  v_fmac_f32 v14, v20, v17
  v_fmac_f32 v15, v21, v17
  s_waitcnt vmcnt(3)
  buffer_load_dwordx4 v[160:163], v2, s[36:39], s83 offen offset:2048 nt
  v_lshlrev_b32 v20, 16, v144
  v_and_b32 v21, 0xffff0000, v144
  v_fmac_f32 v8, v20, v18
  v_fmac_f32 v9, v21, v18
  v_lshlrev_b32 v20, 16, v145
  v_and_b32 v21, 0xffff0000, v145
  v_fmac_f32 v10, v20, v18
  v_fmac_f32 v11, v21, v18
  v_lshlrev_b32 v20, 16, v146
  v_and_b32 v21, 0xffff0000, v146
  v_fmac_f32 v12, v20, v18
  v_fmac_f32 v13, v21, v18
  v_lshlrev_b32 v20, 16, v147
  v_and_b32 v21, 0xffff0000, v147
  v_fmac_f32 v14, v20, v18
  v_fmac_f32 v15, v21, v18
  s_waitcnt vmcnt(3)
  buffer_load_dwordx4 v[164:167], v2, s[36:39], s83 offen offset:3072 nt
  v_lshlrev_b32 v20, 16, v148
  v_and_b32 v21, 0xffff0000, v148
  v_fmac_f32 v8, v20, v19
  v_fmac_f32 v9, v21, v19
  v_lshlrev_b32 v20, 16, v149
  v_and_b32 v21, 0xffff0000, v149
  v_fmac_f32 v10, v20, v19
  v_fmac_f32 v11, v21, v19
  v_lshlrev_b32 v20, 16, v150
  v_and_b32 v21, 0xffff0000, v150
  v_fmac_f32 v12, v20, v19
  v_fmac_f32 v13, v21, v19
  v_lshlrev_b32 v20, 16, v151
  v_and_b32 v21, 0xffff0000, v151
  v_fmac_f32 v14, v20, v19
  v_fmac_f32 v15, v21, v19
  s_waitcnt lgkmcnt(0)
  s_waitcnt vmcnt(3)
  v_lshlrev_b32 v20, 16, v152
  v_and_b32 v21, 0xffff0000, v152
  v_fmac_f32 v8, v20, v24
  v_fmac_f32 v9, v21, v24
  v_lshlrev_b32 v20, 16, v153
  v_and_b32 v21, 0xffff0000, v153
  v_fmac_f32 v10, v20, v24
  v_fmac_f32 v11, v21, v24
  v_lshlrev_b32 v20, 16, v154
  v_and_b32 v21, 0xffff0000, v154
  v_fmac_f32 v12, v20, v24
  v_fmac_f32 v13, v21, v24
  v_lshlrev_b32 v20, 16, v155
  v_and_b32 v21, 0xffff0000, v155
  v_fmac_f32 v14, v20, v24
  v_fmac_f32 v15, v21, v24
  buffer_load_dwordx4 v[168:171], v5, s[52:55], 0 offen nt
  buffer_load_dwordx4 v[172:175], v4, s[44:47], 0 offen offset:0 nt
  buffer_load_dwordx4 v[176:179], v4, s[44:47], 0 offen offset:896 nt
  s_waitcnt vmcnt(5)
  v_lshlrev_b32 v20, 16, v156
  v_and_b32 v21, 0xffff0000, v156
  v_fmac_f32 v8, v20, v25
  v_fmac_f32 v9, v21, v25
  v_lshlrev_b32 v20, 16, v157
  v_and_b32 v21, 0xffff0000, v157
  v_fmac_f32 v10, v20, v25
  v_fmac_f32 v11, v21, v25
  v_lshlrev_b32 v20, 16, v158
  v_and_b32 v21, 0xffff0000, v158
  v_fmac_f32 v12, v20, v25
  v_fmac_f32 v13, v21, v25
  v_lshlrev_b32 v20, 16, v159
  v_and_b32 v21, 0xffff0000, v159
  v_fmac_f32 v14, v20, v25
  v_fmac_f32 v15, v21, v25
  s_waitcnt vmcnt(4)
  v_lshlrev_b32 v20, 16, v160
  v_and_b32 v21, 0xffff0000, v160
  v_fmac_f32 v8, v20, v26
  v_fmac_f32 v9, v21, v26
  v_lshlrev_b32 v20, 16, v161
  v_and_b32 v21, 0xffff0000, v161
  v_fmac_f32 v10, v20, v26
  v_fmac_f32 v11, v21, v26
  v_lshlrev_b32 v20, 16, v162
  v_and_b32 v21, 0xffff0000, v162
  v_fmac_f32 v12, v20, v26
  v_fmac_f32 v13, v21, v26
  v_lshlrev_b32 v20, 16, v163
  v_and_b32 v21, 0xffff0000, v163
  v_fmac_f32 v14, v20, v26
  v_fmac_f32 v15, v21, v26
  s_waitcnt vmcnt(3)
  v_lshlrev_b32 v20, 16, v164
  v_and_b32 v21, 0xffff0000, v164
  v_fmac_f32 v8, v20, v27
  v_fmac_f32 v9, v21, v27
  v_lshlrev_b32 v20, 16, v165
  v_and_b32 v21, 0xffff0000, v165
  v_fmac_f32 v10, v20, v27
  v_fmac_f32 v11, v21, v27
  v_lshlrev_b32 v20, 16, v166
  v_and_b32 v21, 0xffff0000, v166
  v_fmac_f32 v12, v20, v27
  v_fmac_f32 v13, v21, v27
  v_lshlrev_b32 v20, 16, v167
  v_and_b32 v21, 0xffff0000, v167
  v_fmac_f32 v14, v20, v27
  v_fmac_f32 v15, v21, v27
  v_permlane32_swap_b32 v8, v12
  v_permlane32_swap_b32 v9, v13
  v_permlane32_swap_b32 v10, v14
  v_permlane32_swap_b32 v11, v15
  v_add_f32 v8, v8, v12
  v_add_f32 v9, v9, v13
  v_add_f32 v10, v10, v14
  v_add_f32 v11, v11, v15
  v_mul_f32 v8, s94, v8
  v_mul_f32 v9, s94, v9
  v_mul_f32 v10, s94, v10
  v_mul_f32 v11, s94, v11
  ds_write_b128 v28, v[8:11] offset:4096
  s_mov_b32 s81, 589824
  s_mov_b32 s82, 851968
  s_cmp_lg_u32 s86, 0
  s_waitcnt lgkmcnt(0)
  s_barrier
  ds_read_b64 v[36:37], v59 offset:4096
  ds_read_b64 v[40:41], v59 offset:5120
  v_mov_b32 v39, v32
  s_waitcnt lgkmcnt(0)
  v_add_f32 v36, v36, v40
  v_add_f32 v38, v37, v41
  v_mov_b32 v37, v32
  v_add_f32_dpp v36, v36, v36 quad_perm:[1,0,3,2] row_mask:0xf bank_mask:0xf
  v_add_f32_dpp v38, v38, v38 quad_perm:[1,0,3,2] row_mask:0xf bank_mask:0xf
  s_nop 0
  v_add_f32_dpp v36, v36, v36 quad_perm:[2,3,0,1] row_mask:0xf bank_mask:0xf
  v_add_f32_dpp v38, v38, v38 quad_perm:[2,3,0,1] row_mask:0xf bank_mask:0xf
  s_cbranch_scc1 L_oslow
  buffer_store_dwordx4 v[36:39], v60, s[56:59], s81 offen
  s_branch L_ost
L_oslow:
  buffer_store_dwordx4 v[36:39], v60, s[56:59], s81 offen sc1
L_ost:
  s_cmp_ge_u32 s79, 14
  s_cbranch_scc1 L_red
  buffer_load_dwordx4 v[16:19], v61, s[56:59], s81 offen sc1
  buffer_load_dwordx4 v[20:23], v61, s[56:59], s82 offen sc1
  s_waitcnt vmcnt(2)
  v_dot2_f32_bf16 v236, v168, v44, 0
  v_dot2_f32_bf16 v237, v168, v45, 0
  v_dot2_f32_bf16 v238, v169, v44, 0
  v_dot2_f32_bf16 v239, v169, v45, 0
  v_dot2_f32_bf16 v240, v170, v44, 0
  v_dot2_f32_bf16 v241, v170, v45, 0
  v_dot2_f32_bf16 v242, v171, v44, 0
  v_dot2_f32_bf16 v243, v171, v45, 0
  v_dot2_f32_bf16 v244, v168, v46, 0
  v_dot2_f32_bf16 v245, v168, v47, 0
  v_dot2_f32_bf16 v246, v169, v46, 0
  v_dot2_f32_bf16 v247, v169, v47, 0
  v_dot2_f32_bf16 v248, v170, v46, 0
  v_dot2_f32_bf16 v249, v170, v47, 0
  v_dot2_f32_bf16 v250, v171, v46, 0
  v_dot2_f32_bf16 v251, v171, v47, 0
  v_perm_b32 v30, v176, v172, s84
  v_perm_b32 v176, v176, v172, s85
  v_perm_b32 v172, v177, v173, s84
  v_perm_b32 v177, v177, v173, s85
  v_perm_b32 v173, v178, v174, s84
  v_perm_b32 v178, v178, v174, s85
  v_perm_b32 v174, v179, v175, s84
  v_perm_b32 v179, v179, v175, s85
  v_permlane16_swap_b32 v236, v237
  v_permlane16_swap_b32 v238, v239
  v_permlane16_swap_b32 v240, v241
  v_permlane16_swap_b32 v242, v243
  v_permlane16_swap_b32 v244, v245
  v_permlane16_swap_b32 v246, v247
  v_permlane16_swap_b32 v248, v249
  v_permlane16_swap_b32 v250, v251
  v_add_f32 v236, v236, v237
  v_add_f32 v238, v238, v239
  v_add_f32 v240, v240, v241
  v_add_f32 v242, v242, v243
  v_add_f32 v244, v244, v245
  v_add_f32 v246, v246, v247
  v_add_f32 v248, v248, v249
  v_add_f32 v250, v250, v251
  v_permlane32_swap_b32 v236, v238
  v_permlane32_swap_b32 v240, v242
  v_permlane32_swap_b32 v244, v246
  v_permlane32_swap_b32 v248, v250
  v_add_f32 v236, v236, v238
  v_add_f32 v240, v240, v242
  v_add_f32 v244, v244, v246
  v_add_f32 v248, v248, v250
  v_add_f32_dpp v49, v236, v236 row_ror:8 row_mask:0xf bank_mask:0x3
  v_add_f32_dpp v51, v244, v244 row_ror:8 row_mask:0xf bank_mask:0x3
  s_nop 0
  v_add_f32_dpp v49, v240, v240 row_ror:8 row_mask:0xf bank_mask:0xc
  v_add_f32_dpp v51, v248, v248 row_ror:8 row_mask:0xf bank_mask:0xc
  s_mov_b32 s91, 131072
  s_branch L_ochk
L_opoll:
  buffer_load_dwordx4 v[16:19], v61, s[56:59], s81 offen sc1
  buffer_load_dwordx4 v[20:23], v61, s[56:59], s82 offen sc1
  s_sub_u32 s91, s91, 1
  s_cbranch_scc1 L_ook
L_ochk:
  s_waitcnt vmcnt(0)
  v_cmp_ne_u32 vcc, v17, v32
  v_cmp_ne_u32 s[98:99], v19, v32
  v_cmp_ne_u32 s[4:5], v21, v32
  v_cmp_ne_u32 s[6:7], v23, v32
  s_or_b64 vcc, vcc, s[98:99]
  s_or_b64 s[4:5], s[4:5], s[6:7]
  s_or_b64 vcc, vcc, s[4:5]
  s_cbranch_scc1 L_opoll
L_ook:
  v_add_f32_dpp v16, v16, v16 quad_perm:[1,0,3,2] row_mask:0xf bank_mask:0xf
  v_add_f32_dpp v18, v18, v18 quad_perm:[1,0,3,2] row_mask:0xf bank_mask:0xf
  v_add_f32_dpp v20, v20, v20 quad_perm:[1,0,3,2] row_mask:0xf bank_mask:0xf
  v_add_f32_dpp v22, v22, v22 quad_perm:[1,0,3,2] row_mask:0xf bank_mask:0xf
  v_add_f32_dpp v16, v16, v16 quad_perm:[2,3,0,1] row_mask:0xf bank_mask:0xf
  v_add_f32_dpp v18, v18, v18 quad_perm:[2,3,0,1] row_mask:0xf bank_mask:0xf
  v_add_f32_dpp v20, v20, v20 quad_perm:[2,3,0,1] row_mask:0xf bank_mask:0xf
  v_add_f32_dpp v22, v22, v22 quad_perm:[2,3,0,1] row_mask:0xf bank_mask:0xf
  v_add_f32_dpp v16, v16, v16 row_half_mirror row_mask:0xf bank_mask:0xf
  v_add_f32_dpp v18, v18, v18 row_half_mirror row_mask:0xf bank_mask:0xf
  v_add_f32_dpp v20, v20, v20 row_half_mirror row_mask:0xf bank_mask:0xf
  v_add_f32_dpp v22, v22, v22 row_half_mirror row_mask:0xf bank_mask:0xf
  v_cvt_pk_bf16_f32 v16, v16, v18
  v_cvt_pk_bf16_f32 v20, v20, v22
  v_dot2_f32_bf16 v236, v30, v16, 0
  v_dot2_f32_bf16 v237, v176, v16, 0
  v_dot2_f32_bf16 v238, v172, v16, 0
  v_dot2_f32_bf16 v239, v177, v16, 0
  v_dot2_f32_bf16 v240, v173, v16, 0
  v_dot2_f32_bf16 v241, v178, v16, 0
  v_dot2_f32_bf16 v242, v174, v16, 0
  v_dot2_f32_bf16 v243, v179, v16, 0
  v_dot2_f32_bf16 v244, v30, v20, 0
  v_dot2_f32_bf16 v245, v176, v20, 0
  v_dot2_f32_bf16 v246, v172, v20, 0
  v_dot2_f32_bf16 v247, v177, v20, 0
  v_dot2_f32_bf16 v248, v173, v20, 0
  v_dot2_f32_bf16 v249, v178, v20, 0
  v_dot2_f32_bf16 v250, v174, v20, 0
  v_dot2_f32_bf16 v251, v179, v20, 0
  v_permlane16_swap_b32 v236, v237
  v_permlane16_swap_b32 v238, v239
  v_permlane16_swap_b32 v240, v241
  v_permlane16_swap_b32 v242, v243
  v_permlane16_swap_b32 v244, v245
  v_permlane16_swap_b32 v246, v247
  v_permlane16_swap_b32 v248, v249
  v_permlane16_swap_b32 v250, v251
  v_add_f32 v236, v236, v237
  v_add_f32 v238, v238, v239
  v_add_f32 v240, v240, v241
  v_add_f32 v242, v242, v243
  v_add_f32 v244, v244, v245
  v_add_f32 v246, v246, v247
  v_add_f32 v248, v248, v249
  v_add_f32 v250, v250, v251
  v_permlane32_swap_b32 v236, v238
  v_permlane32_swap_b32 v240, v242
  v_permlane32_swap_b32 v244, v246
  v_permlane32_swap_b32 v248, v250
  v_add_f32 v236, v236, v238
  v_add_f32 v240, v240, v242
  v_add_f32 v244, v244, v246
  v_add_f32 v248, v248, v250
  v_add_f32_dpp v48, v236, v236 row_ror:8 row_mask:0xf bank_mask:0x3
  v_add_f32_dpp v50, v244, v244 row_ror:8 row_mask:0xf bank_mask:0x3
  s_nop 0
  v_add_f32_dpp v48, v240, v240 row_ror:8 row_mask:0xf bank_mask:0xc
  v_add_f32_dpp v50, v248, v248 row_ror:8 row_mask:0xf bank_mask:0xc
  ds_write_b64 v29, v[48:49] offset:12288
  ds_write_b64 v29, v[50:51] offset:12800
  s_mov_b32 s81, 1114112
  s_waitcnt lgkmcnt(0)
  s_barrier
  ds_read_b64 v[36:37], v59 offset:12288
  ds_read_b64 v[40:41], v59 offset:13312
  v_mov_b32 v39, v32
  s_waitcnt lgkmcnt(0)
  v_add_f32 v36, v36, v40
  v_add_f32 v38, v37, v41
  v_mov_b32 v37, v32
  v_add_f32_dpp v36, v36, v36 quad_perm:[1,0,3,2] row_mask:0xf bank_mask:0xf
  v_add_f32_dpp v38, v38, v38 quad_perm:[1,0,3,2] row_mask:0xf bank_mask:0xf
  s_nop 0
  v_add_f32_dpp v36, v36, v36 quad_perm:[2,3,0,1] row_mask:0xf bank_mask:0xf
  v_add_f32_dpp v38, v38, v38 quad_perm:[2,3,0,1] row_mask:0xf bank_mask:0xf
  buffer_store_dwordx4 v[36:39], v58, s[56:59], s81 offen sc1
  s_branch L_fin
L_red:
  s_cmp_eq_u32 s95, 0
  s_cbranch_scc1 L_fin
  v_lshlrev_b32 v20, 16, v92
  v_and_b32 v21, 0xffff0000, v92
  v_lshlrev_b32 v22, 16, v96
  v_and_b32 v26, 0xffff0000, v96
  v_mul_f32 v20, v20, v22
  v_mul_f32 v21, v21, v26
  v_cvt_pk_bf16_f32 v8, v20, v21
  v_lshlrev_b32 v20, 16, v93
  v_and_b32 v21, 0xffff0000, v93
  v_lshlrev_b32 v22, 16, v97
  v_and_b32 v26, 0xffff0000, v97
  v_mul_f32 v20, v20, v22
  v_mul_f32 v21, v21, v26
  v_cvt_pk_bf16_f32 v9, v20, v21
  v_lshlrev_b32 v20, 16, v94
  v_and_b32 v21, 0xffff0000, v94
  v_lshlrev_b32 v22, 16, v98
  v_and_b32 v26, 0xffff0000, v98
  v_mul_f32 v20, v20, v22
  v_mul_f32 v21, v21, v26
  v_cvt_pk_bf16_f32 v10, v20, v21
  v_lshlrev_b32 v20, 16, v95
  v_and_b32 v21, 0xffff0000, v95
  v_lshlrev_b32 v22, 16, v99
  v_and_b32 v26, 0xffff0000, v99
  v_mul_f32 v20, v20, v22
  v_mul_f32 v21, v21, v26
  v_cvt_pk_bf16_f32 v11, v20, v21
  v_lshlrev_b32 v20, 16, v8
  v_and_b32 v21, 0xffff0000, v8
  v_add_f32 v8, v20, v21
  v_lshlrev_b32 v20, 16, v9
  v_and_b32 v21, 0xffff0000, v9
  v_add_f32 v9, v20, v21
  v_lshlrev_b32 v20, 16, v10
  v_and_b32 v21, 0xffff0000, v10
  v_add_f32 v10, v20, v21
  v_lshlrev_b32 v20, 16, v11
  v_and_b32 v21, 0xffff0000, v11
  v_add_f32 v11, v20, v21
  v_add_f32 v8, v8, v9
  v_add_f32 v10, v10, v11
  v_add_f32 v8, v8, v10
  s_nop 1
  v_add_f32_dpp v8, v8, v8 quad_perm:[1,0,3,2] row_mask:0xf bank_mask:0xf
  s_nop 1
  v_add_f32_dpp v8, v8, v8 quad_perm:[2,3,0,1] row_mask:0xf bank_mask:0xf
  s_nop 1
  v_add_f32_dpp v8, v8, v8 row_half_mirror row_mask:0xf bank_mask:0xf
  s_nop 1
  v_add_f32_dpp v8, v8, v8 row_mirror row_mask:0xf bank_mask:0xf
  s_nop 1
  v_add_f32_dpp v8, v8, v8 row_bcast:15 row_mask:0xa bank_mask:0xf
  s_nop 1
  v_add_f32_dpp v8, v8, v8 row_bcast:31 row_mask:0xc bank_mask:0xf
  v_cvt_pk_bf16_f32 v8, v8, v8
  v_and_b32 v8, 0xffff0000, v8
  v_mul_f32 v8, 0xbfb8aa3b, v8
  v_exp_f32 v8, v8
  s_nop 0
  v_add_f32 v8, 1.0, v8
  v_rcp_f32 v8, v8
  s_nop 0
  v_cvt_pk_bf16_f32 v8, v8, v8
  v_and_b32 v8, 0xffff0000, v8
  v_sub_f32 v9, 1.0, v8
  v_cvt_pk_bf16_f32 v9, v9, v9
  v_and_b32 v9, 0xffff0000, v9
  v_readlane_b32 s81, v8, 63
  v_readlane_b32 s82, v9, 63
  v_and_b32 v10, 16, v1
  v_cmp_ne_u32 vcc, 0, v10
  v_lshlrev_b32 v33, 16, v33
  v_mov_b32 v56, s81
  v_mov_b32 v8, s82
  v_cndmask_b32 v33, 0, v33, vcc
  v_cndmask_b32 v56, v56, v8, vcc
  s_mov_b32 s81, 1114112
  s_mov_b32 s91, 131072
  s_mov_b64 s[4:5], -1
  s_mov_b64 s[6:7], -1
  s_mov_b64 s[8:9], -1
  s_mov_b64 s[10:11], -1
L_rpoll:
  s_mov_b64 exec, s[4:5]
  s_cbranch_execz L_rp0
  buffer_load_dwordx4 v[8:11], v62, s[56:59], s81 offen offset:0 sc1
L_rp0:
  s_mov_b64 exec, s[6:7]
  s_cbranch_execz L_rp1
  buffer_load_dwordx4 v[12:15], v62, s[56:59], s81 offen offset:1024 sc1
L_rp1:
  s_mov_b64 exec, s[8:9]
  s_cbranch_execz L_rp2
  buffer_load_dwordx4 v[16:19], v62, s[56:59], s81 offen offset:2048 sc1
L_rp2:
  s_mov_b64 exec, s[10:11]
  s_cbranch_execz L_rp3
  buffer_load_dwordx4 v[20:23], v62, s[56:59], s81 offen offset:3072 sc1
L_rp3:
  s_mov_b64 exec, -1
  s_waitcnt vmcnt(0)
  v_cmp_ne_u32 s[4:5], v9, v32
  v_cmp_ne_u32 s[16:17], v11, v32
  v_cmp_ne_u32 s[6:7], v13, v32
  v_cmp_ne_u32 s[18:19], v15, v32
  v_cmp_ne_u32 s[8:9], v17, v32
  v_cmp_ne_u32 s[20:21], v19, v32
  v_cmp_ne_u32 s[10:11], v21, v32
  v_cmp_ne_u32 s[22:23], v23, v32
  s_or_b64 s[4:5], s[4:5], s[16:17]
  s_or_b64 s[6:7], s[6:7], s[18:19]
  s_or_b64 s[8:9], s[8:9], s[20:21]
  s_or_b64 s[10:11], s[10:11], s[22:23]
  s_or_b64 vcc, s[4:5], s[6:7]
  s_or_b64 s[98:99], s[8:9], s[10:11]
  s_or_b64 vcc, vcc, s[98:99]
  s_cbranch_scc0 L_rok
  s_sleep 2
  s_sub_u32 s91, s91, 1
  s_cbranch_scc0 L_rpoll
L_rok:
  v_add_f32 v8, v8, v12
  v_add_f32 v10, v10, v14
  v_add_f32 v16, v16, v20
  v_add_f32 v18, v18, v22
  v_add_f32 v8, v8, v16
  v_add_f32 v10, v10, v18
  s_nop 1
  v_permlane16_swap_b32 v8, v10
  v_add_f32 v8, v8, v10
  s_nop 1
  v_add_f32_dpp v8, v8, v8 row_ror:8 row_mask:0xf bank_mask:0xf
  v_mov_b32 v9, v8
  s_nop 1
  v_permlane32_swap_b32 v8, v9
  v_add_f32 v8, v8, v9
  v_cvt_pk_bf16_f32 v8, v8, v8
  v_and_b32 v8, 0xffff0000, v8
  v_add_f32 v8, v8, v33
  v_cvt_pk_bf16_f32 v8, v8, v8
  v_and_b32 v8, 0xffff0000, v8
  v_mul_f32 v8, v8, v56
  v_cvt_pk_bf16_f32 v8, v8, v8
  v_and_b32 v8, 0xffff0000, v8
  v_mov_b32 v9, v8
  s_nop 1
  v_permlane16_swap_b32 v8, v9
  v_add_f32 v8, v8, v9
  s_nop 1
  v_mov_b32_dpp v9, v8 quad_perm:[1,0,3,2] row_mask:0xf bank_mask:0xf
  v_cvt_pk_bf16_f32 v8, v8, v9
  buffer_store_dword v8, v57, s[72:75], 0 offen
  s_cmp_lg_u32 s90, 0
  s_cbranch_scc1 L_fin
  v_mov_b32 v9, 0
  s_mov_b64 exec, 1
  buffer_store_dword v32, v9, s[56:59], 0 offen offset:0 sc1
  s_mov_b64 exec, -1
L_fin:
L_end:
  s_endpgm
.section .rodata,"a"
.p2align 6
.amdhsa_kernel gated_mix__mha_block_cached__dense_activation_squared_relu__decode_kernel
  .amdhsa_next_free_vgpr 256
  .amdhsa_next_free_sgpr 102
  .amdhsa_accum_offset 256
  .amdhsa_group_segment_fixed_size 0
  .amdhsa_kernarg_size 112
  .amdhsa_user_sgpr_count 2
  .amdhsa_user_sgpr_kernarg_segment_ptr 1
  .amdhsa_system_sgpr_workgroup_id_x 1
  .amdhsa_float_denorm_mode_32 3
.end_amdhsa_kernel
```
